```python
import torch

def _softmax(x, axis=-1):
    return torch.softmax(x, dim=axis)
def _gelu(x):
    return torch.nn.functional.gelu(x, approximate="tanh")
def _silu(x):
    return torch.nn.functional.silu(x)
def _sigmoid(x):
    return torch.sigmoid(x)
def _layernorm(x, axis=-1, eps=1e-5):
    m = x.mean(dim=axis, keepdim=True)
    v = x.var(dim=axis, keepdim=True, unbiased=False)
    return (x - m) / torch.sqrt(v + eps)
def _scatter_add(tgt, idx, src, axis=0):
    return tgt.clone().index_add_(axis, idx, src)
def _segment_sum(src, seg, n):
    out = torch.zeros((n,) + src.shape[1:], dtype=src.dtype)
    return out.index_add_(0, seg, src)
def _pad(x, pw):
    flat = tuple(v for pair in reversed(pw) for v in pair)
    return torch.nn.functional.pad(x, flat)

kernel_name = 'concat_heads__sliding_local_dilated__sliding_block__prompt'

def setup_inputs():

    _w = (lambda a: (lambda t: t.to(torch.bfloat16) if t.is_floating_point() else t)(torch.as_tensor(a)))
    def _A_setup():
        B, S, D = 1, 2048, 512
        return {
            "x": _w((lambda *s: torch.randn(*s, dtype=torch.bfloat16) * 0.2)(B, S, D)),
            "wqkv": _w((lambda *s: torch.randn(*s, dtype=torch.bfloat16) * 0.2)(D, 3 * D)),
            "wo": _w((lambda *s: torch.randn(*s, dtype=torch.bfloat16) * 0.05)(D, D)),
        }
    _A_in = _A_setup()

    def _B_setup():
        B, S, D = 1, 2048, 512
        return {
            "x": _w((lambda *s: torch.randn(*s, dtype=torch.bfloat16) * 0.2)(B, S, D)),
            "wqkv": _w((lambda *s: torch.randn(*s, dtype=torch.bfloat16) * 0.2)(D, 3 * D)),
            "wo": _w((lambda *s: torch.randn(*s, dtype=torch.bfloat16) * 0.05)(D, D)),
        }
    _B_in = _B_setup()

    return {
        "A_x": _A_in["x"],
        "A_wqkv": _A_in["wqkv"],
        "A_wo": _A_in["wo"],
        "B_x": _B_in["x"],
        "B_wqkv": _B_in["wqkv"],
        "B_wo": _B_in["wo"],
    }

def reference(A_x, A_wqkv, A_wo, B_x, B_wqkv, B_wo):
    def _A_ref(x, wqkv, wo):
        B, S, D = x.shape
        H = 32; Dh = D // H
        W, dil = 8, 2
        qkv = (lambda x, *d: x.permute(*d))((x @ wqkv).reshape(B, S, 3, H, Dh), 2, 0, 3, 1, 4)
        q, k, v = qkv[0], qkv[1], qkv[2]
        scale = Dh ** -0.5
        pos = torch.arange(S)
        off = torch.arange(W) * dil
        idx = pos[:, None] - off[None, :]
        mask = idx >= 0
        idx_c = torch.where(mask, idx, 0).reshape(-1)
        kg = k[:, :, idx_c, :].reshape(B, H, S, W, Dh)
        vg = v[:, :, idx_c, :].reshape(B, H, S, W, Dh)
        logits = torch.einsum("bhsd,bhswd->bhsw", q, kg) * scale
        logits = torch.where(mask[None, None, :, :], logits, -1e9)
        attn = _softmax(logits, axis=-1)
        o = torch.einsum("bhsw,bhswd->bhsd", attn, vg)
        return (lambda x, *d: x.permute(*d))(o, 0, 2, 1, 3).reshape(B, S, D) @ wo

    def _B_ref(x, wqkv, wo):
        B, S, D = x.shape
        H = 32; Dh = D // H; W = 256
        qkv = (lambda x, *d: x.permute(*d))((x @ wqkv).reshape(B, S, 3, H, Dh), 2, 0, 3, 1, 4)
        q, k, v = qkv[0], qkv[1], qkv[2]
        scores = torch.einsum("bhqd,bhkd->bhqk", q, k) * (Dh ** -0.5)
        idx = torch.arange(S)
        mask = (idx[:, None] - idx[None, :] >= 0) & (idx[:, None] - idx[None, :] < W)
        scores = torch.where(mask[None, None], scores, -1e9)
        p = _softmax(scores, axis=-1)
        o = torch.einsum("bhqk,bhkd->bhqd", p, v)
        return (lambda x, *d: x.permute(*d))(o, 0, 2, 1, 3).reshape(B, S, D) @ wo

    a = _A_ref(A_x, A_wqkv, A_wo)
    b = _B_ref(B_x, B_wqkv, B_wo)
    return torch.concatenate([a, b], axis=-1)
```

```asm
; @launch grid=(256,1,1) block=(512,1,1) lds=163840
.amdgcn_target "amdgcn-amd-amdhsa--gfx950"
.text
.globl concat_heads__sliding_local_dilated__sliding_block__prompt_kernel
.p2align 12
.p2align 8
.type concat_heads__sliding_local_dilated__sliding_block__prompt_kernel,@function
concat_heads__sliding_local_dilated__sliding_block__prompt_kernel:
s_load_dwordx16 s[16:31], s[0:1], 0
s_load_dwordx2 s[40:41], s[0:1], 64
v_readfirstlane_b32 s3, v0
s_cmpk_ge_u32 s2, 256
s_cbranch_scc1 L_end
v_and_b32 v1, 63, v0
s_and_b32 s8, s2, 7
s_and_b32 s4, s2, 1
s_lshr_b32 s9, s2, 3
s_lshr_b32 s3, s3, 6
s_and_b32 s56, s9, 7
s_lshr_b32 s57, s9, 3
s_and_b32 s5, s2, 2
s_lshl2_add_u32 s5, s5, s56
s_and_b32 s6, s2, 4
s_add_u32 s6, s6, s57
s_and_b32 s14, s3, 3
s_mov_b32 s43, 0x20000
s_cmp_ge_u32 s3, 4
s_cbranch_scc0 L_compute
s_lshl1_add_u32 s64, s57, s56
s_and_b32 s64, s64, 7
v_lshrrev_b32 v7, 3, v1
v_and_b32 v8, 7, v1
v_lshrrev_b32 v9, 4, v1
s_and_b32 s56, s14, 1
v_lshl_add_u32 v10, s56, 2, v9
v_xor_b32 v10, v10, v8
v_lshlrev_b32 v10, 4, v10
v_lshl_add_u32 v4, v7, 10, v10
v_and_b32 v10, 1, v9
v_lshl_add_u32 v10, v10, 1, s56
v_lshlrev_b32 v10, 1, v10
v_xor_b32 v10, v10, v8
v_lshlrev_b32 v10, 4, v10
s_movk_i32 s56, 3072
v_mad_u32_u24 v6, v7, s56, v10
s_lshl4_add_u32 s61, s5, s14
s_lshl_b32 s61, s61, 13
s_mul_i32 s62, s14, 48
s_lshl2_add_u32 s62, s62, s6
s_lshl_b32 s62, s62, 7
s_lshl_b32 s65, s14, 10
s_mov_b32 s66, 0
s_lshl_b32 s34, 1, 21
s_mov_b32 s35, s43
s_lshl_b32 s38, 3, 19
s_lshl_b32 s54, 1, 15
s_mov_b32 s39, s43
s_cmp_eq_u32 s4, 0
s_cbranch_scc1 L_ldA
s_waitcnt lgkmcnt(0)
s_mov_b64 s[32:33], s[22:23]
s_mov_b64 s[36:37], s[24:25]
L_ld_b:
s_lshl_b32 s70, s64, 7
s_add_u32 s68, s61, s70
s_add_u32 m0, s65, 24576
s_mul_i32 s69, s64, 196608
buffer_load_dwordx4 v4, s[32:35], s68 offen lds
s_addk_i32 m0, 4096
s_add_u32 s68, s68, s54
buffer_load_dwordx4 v4, s[32:35], s68 offen lds
s_addk_i32 m0, 4096
s_add_u32 s68, s68, s54
buffer_load_dwordx4 v4, s[32:35], s68 offen lds
s_addk_i32 m0, 4096
s_add_u32 s68, s68, s54
buffer_load_dwordx4 v4, s[32:35], s68 offen lds
s_mov_b32 m0, s65
s_add_u32 s69, s69, s62
buffer_load_dwordx4 v6, s[36:39], s69 offen lds
s_addk_i32 m0, 8192
s_addk_i32 s69, 1024
buffer_load_dwordx4 v6, s[36:39], s69 offen lds
s_addk_i32 m0, 8192
s_addk_i32 s69, 1024
buffer_load_dwordx4 v6, s[36:39], s69 offen lds
s_addk_i32 m0, -12288
s_add_u32 s69, s69, 96256
buffer_load_dwordx4 v6, s[36:39], s69 offen lds
s_addk_i32 m0, 8192
s_addk_i32 s69, 1024
buffer_load_dwordx4 v6, s[36:39], s69 offen lds
s_addk_i32 m0, 8192
s_addk_i32 s69, 1024
buffer_load_dwordx4 v6, s[36:39], s69 offen lds
s_add_u32 s64, s64, 1
s_and_b32 s64, s64, 7
s_add_u32 s65, s65, 43008
s_cmp_ge_u32 s65, 129024
s_cselect_b32 s56, 129024, 0
s_sub_u32 s65, s65, s56
s_add_u32 s66, s66, 1
s_cmp_lt_u32 s66, 2
s_cbranch_scc1 L_ld_b1
s_cmp_lg_u32 s66, 8
s_cbranch_scc1 L_np_b
s_mov_b64 s[48:49], s[26:27]
s_mov_b32 s50, 524288
s_mov_b32 s51, s43
s_lshl2_add_u32 s71, s9, s14
s_lshl_b32 s71, s71, 12
v_and_b32 v12, 31, v1
v_lshlrev_b32 v12, 7, v12
buffer_load_dword v220, v12, s[48:51], s71 offen
s_waitcnt vmcnt(11)
s_barrier
s_branch L_ld_done
L_np_b:
s_waitcnt vmcnt(10) lgkmcnt(0)
s_barrier
s_branch L_ld_b
L_ld_b1:
s_load_dwordx2 s[10:11], s[40:41], 0
s_branch L_ld_b
L_ldA:
v_and_b32 v10, 1, v9
v_lshlrev_b32 v10, 2, v10
v_xor_b32 v10, v10, v8
v_lshlrev_b32 v10, 4, v10
v_lshl_add_u32 v11, v7, 10, v10
s_lshr_b32 s59, s9, 3
s_lshl_b32 s59, s59, 8
s_and_b32 s57, s9, 7
s_lshl_b32 s57, s57, 3
s_add_u32 s57, s57, s14
s_mov_b32 s50, 524288
s_mov_b32 s51, s43
s_mov_b32 s60, 86016
s_add_u32 s59, s59, 128
s_waitcnt lgkmcnt(0)
s_mov_b64 s[48:49], s[20:21]
s_mov_b32 s58, 2
L_apre0:
s_lshl_b32 s56, s57, 10
s_add_u32 m0, s56, s60
s_lshl_b32 s56, s57, 13
s_add_u32 s56, s56, s59
buffer_load_dwordx4 v11, s[48:51], s56 offen lds
s_add_u32 s57, s57, 4
s_and_b32 s57, s57, 63
s_sub_u32 s58, s58, 1
s_cmp_lg_u32 s58, 0
s_cbranch_scc1 L_apre0
s_mov_b32 s60, 0
s_sub_u32 s59, s59, 128
s_mov_b32 s67, s57
s_sub_u32 s57, s57, 8
s_and_b32 s57, s57, 63
s_mov_b32 s58, 16
L_apre1:
s_lshl_b32 s56, s57, 10
s_add_u32 m0, s56, s60
s_lshl_b32 s56, s57, 13
s_add_u32 s56, s56, s59
buffer_load_dwordx4 v11, s[48:51], s56 offen lds
s_add_u32 s57, s57, 4
s_and_b32 s57, s57, 63
s_sub_u32 s58, s58, 1
s_cmp_lg_u32 s58, 0
s_cbranch_scc1 L_apre1
s_mov_b32 s60, 86016
s_add_u32 s59, s59, 128
s_mov_b32 s57, s67
s_mov_b32 s58, 6
L_apre2:
s_lshl_b32 s56, s57, 10
s_add_u32 m0, s56, s60
s_lshl_b32 s56, s57, 13
s_add_u32 s56, s56, s59
buffer_load_dwordx4 v11, s[48:51], s56 offen lds
s_add_u32 s57, s57, 4
s_and_b32 s57, s57, 63
s_sub_u32 s58, s58, 1
s_cmp_lg_u32 s58, 0
s_cbranch_scc1 L_apre2
s_load_dwordx2 s[10:11], s[40:41], 0
s_mov_b64 s[32:33], s[16:17]
s_mov_b64 s[36:37], s[18:19]
s_lshl_b32 s56, s14, 1
v_add_u32 v10, s56, v9
v_and_b32 v10, 7, v10
v_xor_b32 v10, v10, v8
v_lshlrev_b32 v10, 4, v10
v_lshl_add_u32 v5, v7, 10, v10
s_lshl_b32 s63, s5, 17
s_lshl_b32 s56, s14, 12
s_add_u32 s63, s63, s56
s_sub_u32 s63, s63, 16384
s_cmp_lg_u32 s5, 0
s_cbranch_scc1 L_ld_halo_ok
s_mov_b32 s63, 0
v_mov_b32 v5, 0x7fff0000
L_ld_halo_ok:
s_mov_b32 s67, s57
v_lshlrev_b32 v208, 4, v1
v_lshrrev_b32 v2, 2, v1
v_bfe_u32 v3, v1, 3, 2
v_and_b32 v212, 3, v1
v_xor_b32 v3, v3, v212
v_lshlrev_b32 v3, 4, v3
v_lshl_add_u32 v212, v2, 11, v3
s_mov_b32 s42, 13631488
s_mov_b32 s44, s28
s_mov_b32 s45, s29
s_mov_b32 s46, 4194304
s_mov_b32 s47, 0x20000
s_mov_b32 s72, 0xffff
s_mov_b32 s73, 0xffff
s_lshr_b32 s56, s8, 1
s_lshl_b32 s56, s56, 3
s_and_b32 s12, s9, 7
s_add_u32 s12, s12, s56
s_lshl_b32 s13, s8, 2
s_and_b32 s56, s9, 3
s_add_u32 s13, s13, s56
s_lshl_b32 s7, s13, 5
s_and_b32 s56, s9, 28
s_add_u32 s7, s7, s56
s_add_u32 s7, s7, s14
s_lshl_b32 s7, s7, 7
s_add_u32 s7, s7, 262144
s_lshl_b32 s56, s12, 3
s_lshr_b32 s57, s9, 3
s_add_u32 s56, s56, s57
s_add_u32 s56, s56, 256
s_lshl_b32 s57, s5, 3
s_add_u32 s57, s57, s6
s_add_u32 s57, s57, 8
s_cmp_eq_u32 s4, 0
s_cselect_b32 s56, s56, s57
s_lshl_b32 s56, s56, 2
s_add_u32 s56, s56, s14
s_lshl_b32 s15, s56, 7
s_lshl_b32 s30, s5, 6
s_and_b32 s56, s6, 1
s_add_u32 s30, s30, s56
s_lshl_b32 s30, s30, 4
s_lshr_b32 s56, s6, 1
s_add_u32 s30, s30, s56
s_lshl_b32 s30, s30, 3
s_add_u32 s30, s30, 131072
v_lshrrev_b32 v2, 3, v1
v_and_b32 v3, 7, v1
v_lshlrev_b32 v3, 8, v3
v_lshl_add_u32 v214, v2, 12, v3
s_lshl_b32 s22, s12, 17
s_lshr_b32 s56, s9, 3
s_lshl_b32 s56, s56, 8
s_add_u32 s22, s22, s56
s_lshl_b32 s56, s14, 6
s_add_u32 s22, s22, s56
s_add_u32 s24, s22, 65536
s_lshl_b32 s56, s14, 12
s_add_u32 s56, s56, 65536
v_add_u32 v218, s56, v208
v_and_b32 v2, 31, v1
v_lshrrev_b32 v3, 5, v1
v_bfe_u32 v216, v1, 1, 2
v_xor_b32 v3, v3, v216
v_lshlrev_b32 v3, 4, v3
v_lshl_add_u32 v2, v2, 6, v3
v_add_u32 v216, s56, v2
v_xor_b32 v217, 32, v216
s_mov_b32 s57, s67
s_waitcnt vmcnt(6)
s_barrier
s_cmp_ge_u32 s14, 2
s_cbranch_scc1 L_ap3
v_lshrrev_b32 v9, 5, v1
v_bfe_u32 v10, v1, 2, 2
v_lshl_add_u32 v10, v9, 2, v10
v_lshlrev_b32 v10, 7, v10
v_bfe_u32 v9, v1, 3, 1
s_and_b32 s56, s14, 1
v_xor_b32 v9, s56, v9
v_lshl_add_u32 v10, v9, 6, v10
v_bfe_u32 v9, v1, 4, 1
v_lshl_add_u32 v10, v9, 5, v10
v_and_b32 v9, 3, v1
v_lshl_add_u32 v10, v9, 3, v10
ds_read_b64_tr_b16 v[64:65], v10 offset:0
ds_read_b64_tr_b16 v[66:67], v10 offset:1024
ds_read_b64_tr_b16 v[68:69], v10 offset:2048
ds_read_b64_tr_b16 v[70:71], v10 offset:3072
ds_read_b64_tr_b16 v[72:73], v10 offset:4096
ds_read_b64_tr_b16 v[74:75], v10 offset:5120
ds_read_b64_tr_b16 v[76:77], v10 offset:6144
ds_read_b64_tr_b16 v[78:79], v10 offset:7168
ds_read_b64_tr_b16 v[80:81], v10 offset:8192
ds_read_b64_tr_b16 v[82:83], v10 offset:9216
ds_read_b64_tr_b16 v[84:85], v10 offset:10240
ds_read_b64_tr_b16 v[86:87], v10 offset:11264
ds_read_b64_tr_b16 v[88:89], v10 offset:12288
ds_read_b64_tr_b16 v[90:91], v10 offset:13312
ds_read_b64_tr_b16 v[92:93], v10 offset:14336
ds_read_b64_tr_b16 v[94:95], v10 offset:15360
ds_read_b64_tr_b16 v[96:97], v10 offset:16384
ds_read_b64_tr_b16 v[98:99], v10 offset:17408
ds_read_b64_tr_b16 v[100:101], v10 offset:18432
ds_read_b64_tr_b16 v[102:103], v10 offset:19456
ds_read_b64_tr_b16 v[104:105], v10 offset:20480
ds_read_b64_tr_b16 v[106:107], v10 offset:21504
ds_read_b64_tr_b16 v[108:109], v10 offset:22528
ds_read_b64_tr_b16 v[110:111], v10 offset:23552
ds_read_b64_tr_b16 v[112:113], v10 offset:24576
ds_read_b64_tr_b16 v[114:115], v10 offset:25600
ds_read_b64_tr_b16 v[116:117], v10 offset:26624
ds_read_b64_tr_b16 v[118:119], v10 offset:27648
ds_read_b64_tr_b16 v[120:121], v10 offset:28672
ds_read_b64_tr_b16 v[122:123], v10 offset:29696
ds_read_b64_tr_b16 v[124:125], v10 offset:30720
ds_read_b64_tr_b16 v[126:127], v10 offset:31744
ds_read_b64_tr_b16 v[128:129], v10 offset:32768
ds_read_b64_tr_b16 v[130:131], v10 offset:33792
ds_read_b64_tr_b16 v[132:133], v10 offset:34816
ds_read_b64_tr_b16 v[134:135], v10 offset:35840
ds_read_b64_tr_b16 v[136:137], v10 offset:36864
ds_read_b64_tr_b16 v[138:139], v10 offset:37888
ds_read_b64_tr_b16 v[140:141], v10 offset:38912
ds_read_b64_tr_b16 v[142:143], v10 offset:39936
ds_read_b64_tr_b16 v[144:145], v10 offset:40960
ds_read_b64_tr_b16 v[146:147], v10 offset:41984
ds_read_b64_tr_b16 v[148:149], v10 offset:43008
ds_read_b64_tr_b16 v[150:151], v10 offset:44032
ds_read_b64_tr_b16 v[152:153], v10 offset:45056
ds_read_b64_tr_b16 v[154:155], v10 offset:46080
ds_read_b64_tr_b16 v[156:157], v10 offset:47104
ds_read_b64_tr_b16 v[158:159], v10 offset:48128
ds_read_b64_tr_b16 v[160:161], v10 offset:49152
ds_read_b64_tr_b16 v[162:163], v10 offset:50176
ds_read_b64_tr_b16 v[164:165], v10 offset:51200
ds_read_b64_tr_b16 v[166:167], v10 offset:52224
ds_read_b64_tr_b16 v[168:169], v10 offset:53248
ds_read_b64_tr_b16 v[170:171], v10 offset:54272
ds_read_b64_tr_b16 v[172:173], v10 offset:55296
ds_read_b64_tr_b16 v[174:175], v10 offset:56320
ds_read_b64_tr_b16 v[176:177], v10 offset:57344
ds_read_b64_tr_b16 v[178:179], v10 offset:58368
ds_read_b64_tr_b16 v[180:181], v10 offset:59392
ds_read_b64_tr_b16 v[182:183], v10 offset:60416
ds_read_b64_tr_b16 v[184:185], v10 offset:61440
ds_read_b64_tr_b16 v[186:187], v10 offset:62464
ds_read_b64_tr_b16 v[188:189], v10 offset:63488
ds_read_b64_tr_b16 v[190:191], v10 offset:64512
L_ap3:
s_mov_b32 s58, 8
L_apre3:
s_lshl_b32 s56, s57, 10
s_add_u32 m0, s56, s60
s_lshl_b32 s56, s57, 13
s_add_u32 s56, s56, s59
buffer_load_dwordx4 v11, s[48:51], s56 offen lds
s_add_u32 s57, s57, 4
s_and_b32 s57, s57, 63
s_sub_u32 s58, s58, 1
s_cmp_lg_u32 s58, 0
s_cbranch_scc1 L_apre3
s_mov_b32 s67, s57
s_waitcnt lgkmcnt(0)
s_mul_i32 s10, s10, 0x9e3779b1
s_add_u32 s10, s10, 0x7f4a7c15
s_mul_i32 s11, s11, 0x2c9277b5
s_add_u32 s11, s11, 0xac564b05
s_xor_b32 s11, s11, s10
s_barrier
L_ld_a:
s_lshl_b32 s70, s64, 7
s_add_u32 s68, s61, s70
s_add_u32 m0, s65, 24576
s_mul_i32 s69, s64, 196608
buffer_load_dwordx4 v4, s[32:35], s68 offen lds
s_addk_i32 m0, 4096
s_add_u32 s68, s68, s54
buffer_load_dwordx4 v4, s[32:35], s68 offen lds
s_addk_i32 m0, 4096
s_add_u32 s68, s68, s54
buffer_load_dwordx4 v4, s[32:35], s68 offen lds
s_addk_i32 m0, 4096
s_add_u32 s68, s68, s54
buffer_load_dwordx4 v4, s[32:35], s68 offen lds
s_lshl_b32 s57, s14, 9
s_sub_u32 s57, s65, s57
s_add_u32 m0, s57, 40960
s_add_u32 s56, s63, s70
s_mov_b32 exec_hi, 0
buffer_load_dwordx4 v5, s[32:35], s56 offen lds
s_mov_b32 exec_hi, -1
s_mov_b32 m0, s65
s_add_u32 s69, s69, s62
buffer_load_dwordx4 v6, s[36:39], s69 offen lds
s_addk_i32 m0, 8192
s_addk_i32 s69, 1024
buffer_load_dwordx4 v6, s[36:39], s69 offen lds
s_addk_i32 m0, 8192
s_addk_i32 s69, 1024
buffer_load_dwordx4 v6, s[36:39], s69 offen lds
s_addk_i32 m0, -12288
s_add_u32 s69, s69, 96256
buffer_load_dwordx4 v6, s[36:39], s69 offen lds
s_addk_i32 m0, 8192
s_addk_i32 s69, 1024
buffer_load_dwordx4 v6, s[36:39], s69 offen lds
s_addk_i32 m0, 8192
s_addk_i32 s69, 1024
buffer_load_dwordx4 v6, s[36:39], s69 offen lds
s_add_u32 s64, s64, 1
s_and_b32 s64, s64, 7
s_add_u32 s65, s65, 43008
s_cmp_ge_u32 s65, 129024
s_cselect_b32 s56, 129024, 0
s_sub_u32 s65, s65, s56
s_add_u32 s66, s66, 1
s_cmp_lt_u32 s66, 2
s_cbranch_scc1 L_ld_a1
s_cmp_lg_u32 s66, 8
s_cbranch_scc1 L_np_a
s_mov_b64 s[48:49], s[26:27]
s_mov_b32 s50, 524288
s_mov_b32 s51, s43
s_lshl2_add_u32 s71, s9, s14
s_lshl_b32 s71, s71, 12
v_and_b32 v12, 31, v1
v_lshlrev_b32 v12, 7, v12
buffer_load_dword v220, v12, s[48:51], s71 offen
s_waitcnt vmcnt(12)
s_barrier
s_branch L_ld_done
L_np_a:
s_waitcnt vmcnt(11) lgkmcnt(0)
s_barrier
s_branch L_ld_a
L_ld_a1:
s_waitcnt vmcnt(11)
s_barrier
s_cmp_lt_u32 s14, 2
s_cbranch_scc1 L_ld_a
v_lshrrev_b32 v9, 5, v1
v_bfe_u32 v10, v1, 2, 2
v_lshl_add_u32 v10, v9, 2, v10
v_lshlrev_b32 v10, 7, v10
v_bfe_u32 v9, v1, 3, 1
s_and_b32 s56, s14, 1
v_xor_b32 v9, s56, v9
v_lshl_add_u32 v10, v9, 6, v10
v_bfe_u32 v9, v1, 4, 1
v_lshl_add_u32 v10, v9, 5, v10
v_and_b32 v9, 3, v1
v_lshl_add_u32 v10, v9, 3, v10
v_add_u32 v10, 86016, v10
ds_read_b64_tr_b16 v[64:65], v10 offset:0
ds_read_b64_tr_b16 v[66:67], v10 offset:1024
ds_read_b64_tr_b16 v[68:69], v10 offset:2048
ds_read_b64_tr_b16 v[70:71], v10 offset:3072
ds_read_b64_tr_b16 v[72:73], v10 offset:4096
ds_read_b64_tr_b16 v[74:75], v10 offset:5120
ds_read_b64_tr_b16 v[76:77], v10 offset:6144
ds_read_b64_tr_b16 v[78:79], v10 offset:7168
ds_read_b64_tr_b16 v[80:81], v10 offset:8192
ds_read_b64_tr_b16 v[82:83], v10 offset:9216
ds_read_b64_tr_b16 v[84:85], v10 offset:10240
ds_read_b64_tr_b16 v[86:87], v10 offset:11264
ds_read_b64_tr_b16 v[88:89], v10 offset:12288
ds_read_b64_tr_b16 v[90:91], v10 offset:13312
ds_read_b64_tr_b16 v[92:93], v10 offset:14336
ds_read_b64_tr_b16 v[94:95], v10 offset:15360
ds_read_b64_tr_b16 v[96:97], v10 offset:16384
ds_read_b64_tr_b16 v[98:99], v10 offset:17408
ds_read_b64_tr_b16 v[100:101], v10 offset:18432
ds_read_b64_tr_b16 v[102:103], v10 offset:19456
ds_read_b64_tr_b16 v[104:105], v10 offset:20480
ds_read_b64_tr_b16 v[106:107], v10 offset:21504
ds_read_b64_tr_b16 v[108:109], v10 offset:22528
ds_read_b64_tr_b16 v[110:111], v10 offset:23552
ds_read_b64_tr_b16 v[112:113], v10 offset:24576
ds_read_b64_tr_b16 v[114:115], v10 offset:25600
ds_read_b64_tr_b16 v[116:117], v10 offset:26624
ds_read_b64_tr_b16 v[118:119], v10 offset:27648
ds_read_b64_tr_b16 v[120:121], v10 offset:28672
ds_read_b64_tr_b16 v[122:123], v10 offset:29696
ds_read_b64_tr_b16 v[124:125], v10 offset:30720
ds_read_b64_tr_b16 v[126:127], v10 offset:31744
ds_read_b64_tr_b16 v[128:129], v10 offset:32768
ds_read_b64_tr_b16 v[130:131], v10 offset:33792
ds_read_b64_tr_b16 v[132:133], v10 offset:34816
ds_read_b64_tr_b16 v[134:135], v10 offset:35840
ds_read_b64_tr_b16 v[136:137], v10 offset:36864
ds_read_b64_tr_b16 v[138:139], v10 offset:37888
ds_read_b64_tr_b16 v[140:141], v10 offset:38912
ds_read_b64_tr_b16 v[142:143], v10 offset:39936
ds_read_b64_tr_b16 v[144:145], v10 offset:40960
ds_read_b64_tr_b16 v[146:147], v10 offset:41984
ds_read_b64_tr_b16 v[148:149], v10 offset:43008
ds_read_b64_tr_b16 v[150:151], v10 offset:44032
ds_read_b64_tr_b16 v[152:153], v10 offset:45056
ds_read_b64_tr_b16 v[154:155], v10 offset:46080
ds_read_b64_tr_b16 v[156:157], v10 offset:47104
ds_read_b64_tr_b16 v[158:159], v10 offset:48128
ds_read_b64_tr_b16 v[160:161], v10 offset:49152
ds_read_b64_tr_b16 v[162:163], v10 offset:50176
ds_read_b64_tr_b16 v[164:165], v10 offset:51200
ds_read_b64_tr_b16 v[166:167], v10 offset:52224
ds_read_b64_tr_b16 v[168:169], v10 offset:53248
ds_read_b64_tr_b16 v[170:171], v10 offset:54272
ds_read_b64_tr_b16 v[172:173], v10 offset:55296
ds_read_b64_tr_b16 v[174:175], v10 offset:56320
ds_read_b64_tr_b16 v[176:177], v10 offset:57344
ds_read_b64_tr_b16 v[178:179], v10 offset:58368
ds_read_b64_tr_b16 v[180:181], v10 offset:59392
ds_read_b64_tr_b16 v[182:183], v10 offset:60416
ds_read_b64_tr_b16 v[184:185], v10 offset:61440
ds_read_b64_tr_b16 v[186:187], v10 offset:62464
ds_read_b64_tr_b16 v[188:189], v10 offset:63488
ds_read_b64_tr_b16 v[190:191], v10 offset:64512
s_branch L_ld_a
.p2align 12
L_ld_done:
s_lshr_b32 s62, s9, 2
s_lshl_b32 s62, s62, 7
s_lshl_b32 s58, s14, 13
s_add_u32 s62, s62, s58
s_lshl_b32 s56, s14, 10
s_add_u32 m0, s56, 98304
v_lshlrev_b32 v7, 4, v1
v_add_u32 v7, 151552, v7
ds_read_b128 v[208:211], v7
s_waitcnt lgkmcnt(0)
buffer_load_dwordx4 v210, s[48:51], s62 offen lds
s_add_u32 m0, m0, 4096
s_add_u32 s62, s62, 32768
buffer_load_dwordx4 v210, s[48:51], s62 offen lds
s_add_u32 m0, m0, 4096
s_add_u32 s62, s62, 32768
buffer_load_dwordx4 v210, s[48:51], s62 offen lds
s_add_u32 m0, m0, 4096
s_add_u32 s62, s62, 32768
buffer_load_dwordx4 v210, s[48:51], s62 offen lds
s_add_u32 m0, m0, 4096
s_add_u32 s62, s62, 32768
s_waitcnt vmcnt(5)
s_barrier
buffer_load_dwordx4 v210, s[48:51], s62 offen lds
s_add_u32 m0, m0, 4096
s_add_u32 s62, s62, 32768
buffer_load_dwordx4 v210, s[48:51], s62 offen lds
s_add_u32 m0, m0, 4096
s_add_u32 s62, s62, 32768
buffer_load_dwordx4 v210, s[48:51], s62 offen lds
s_add_u32 m0, m0, 4096
s_add_u32 s62, s62, 32768
buffer_load_dwordx4 v210, s[48:51], s62 offen lds
s_add_u32 m0, m0, 4096
s_add_u32 s62, s62, 32768
buffer_load_dwordx4 v210, s[48:51], s62 offen lds
s_add_u32 m0, m0, 4096
s_add_u32 s62, s62, 32768
buffer_load_dwordx4 v210, s[48:51], s62 offen lds
s_add_u32 m0, m0, 4096
s_add_u32 s62, s62, 32768
buffer_load_dwordx4 v210, s[48:51], s62 offen lds
s_add_u32 m0, m0, 4096
s_add_u32 s62, s62, 32768
buffer_load_dwordx4 v210, s[48:51], s62 offen lds
s_add_u32 m0, m0, 4096
s_add_u32 s62, s62, 32768
s_cmp_eq_u32 s4, 0
s_cbranch_scc1 L_nocr
s_nop 0
ds_read_b128 v[224:227], v7 offset:2048
ds_read_b128 v[228:231], v7 offset:3072
ds_read_b128 v[232:235], v7 offset:4096
ds_read_b128 v[236:239], v7 offset:5120
ds_read_b128 v[240:243], v7 offset:6144
ds_read_b128 v[244:247], v7 offset:7168
ds_read_b128 v[248:251], v7 offset:8192
ds_read_b128 v[252:255], v7 offset:9216
s_waitcnt lgkmcnt(0)
L_nocr:
s_barrier
buffer_load_dwordx4 v210, s[48:51], s62 offen lds
s_add_u32 m0, m0, 4096
s_add_u32 s62, s62, 32768
buffer_load_dwordx4 v210, s[48:51], s62 offen lds
s_add_u32 m0, m0, 4096
s_add_u32 s62, s62, 32768
buffer_load_dwordx4 v210, s[48:51], s62 offen lds
s_add_u32 m0, m0, 4096
s_add_u32 s62, s62, 32768
buffer_load_dwordx4 v210, s[48:51], s62 offen lds
s_add_u32 m0, m0, 4096
s_add_u32 s62, s62, 32768
s_cmp_lg_u32 s4, 0
s_cbranch_scc1 L_helpB
s_barrier
s_branch L_projA
L_compute:
s_and_b32 s60, s3, 1
s_lshr_b32 s61, s3, 1
s_getpc_b64 s[56:57]
L_pc:
s_sub_u32 s56, s56, L_pc-concat_heads__sliding_local_dilated__sliding_block__prompt_kernel
s_subb_u32 s57, s57, 0
s_lshl_b32 s58, s3, 13
v_lshl_add_u32 v4, v1, 7, s58
v_min_u32 v4, L_end-concat_heads__sliding_local_dilated__sliding_block__prompt_kernel, v4
v_mov_b32_e64 v5, s57
v_add_co_u32 v2, vcc, s56, v4
s_nop 1
v_addc_co_u32 v3, vcc, 0, v5, vcc
global_load_dword v220, v[2:3], off
v_mov_b64 v[96:97], 0
v_mov_b64 v[98:99], 0
v_mov_b64 v[100:101], 0
v_mov_b64 v[102:103], 0
v_mov_b64 v[104:105], 0
v_mov_b64 v[106:107], 0
v_mov_b64 v[108:109], 0
v_mov_b64 v[110:111], 0
v_mov_b64 v[112:113], 0
v_mov_b64 v[114:115], 0
v_mov_b64 v[116:117], 0
v_mov_b64 v[118:119], 0
v_mov_b64 v[120:121], 0
v_mov_b64 v[122:123], 0
v_mov_b64 v[124:125], 0
v_mov_b64 v[126:127], 0
v_mov_b64 v[128:129], 0
v_mov_b64 v[130:131], 0
v_mov_b64 v[132:133], 0
v_mov_b64 v[134:135], 0
v_mov_b64 v[136:137], 0
v_mov_b64 v[138:139], 0
v_mov_b64 v[140:141], 0
v_mov_b64 v[142:143], 0
v_mov_b64 v[144:145], 0
v_mov_b64 v[146:147], 0
v_mov_b64 v[148:149], 0
v_mov_b64 v[150:151], 0
v_mov_b64 v[152:153], 0
v_mov_b64 v[154:155], 0
v_mov_b64 v[156:157], 0
v_mov_b64 v[158:159], 0
v_mov_b64 v[160:161], 0
v_mov_b64 v[162:163], 0
v_mov_b64 v[164:165], 0
v_mov_b64 v[166:167], 0
v_mov_b64 v[168:169], 0
v_mov_b64 v[170:171], 0
v_mov_b64 v[172:173], 0
v_mov_b64 v[174:175], 0
v_mov_b64 v[176:177], 0
v_mov_b64 v[178:179], 0
v_mov_b64 v[180:181], 0
v_mov_b64 v[182:183], 0
v_mov_b64 v[184:185], 0
v_mov_b64 v[186:187], 0
v_mov_b64 v[188:189], 0
v_mov_b64_e64 v[190:191], 0
s_waitcnt lgkmcnt(0)
s_load_dwordx2 s[10:11], s[40:41], 0
s_mov_b32 s42, 13631488
s_mov_b32 s44, s28
s_mov_b32 s45, s29
s_mov_b32 s46, 4194304
s_mov_b32 s47, 0x20000
s_mov_b32 s72, 0xffff
s_mov_b32 s73, 0xffff
s_lshr_b32 s56, s8, 1
s_lshl_b32 s56, s56, 3
s_and_b32 s12, s9, 7
s_add_u32 s12, s12, s56
s_lshl_b32 s13, s8, 2
s_and_b32 s56, s9, 3
s_add_u32 s13, s13, s56
s_lshl_b32 s7, s13, 5
s_and_b32 s56, s9, 28
s_add_u32 s7, s7, s56
s_add_u32 s7, s7, s14
s_lshl_b32 s7, s7, 7
s_add_u32 s7, s7, 262144
s_lshl_b32 s56, s12, 3
s_lshr_b32 s57, s9, 3
s_add_u32 s56, s56, s57
s_add_u32 s56, s56, 256
s_lshl_b32 s57, s5, 3
s_add_u32 s57, s57, s6
s_add_u32 s57, s57, 8
s_cmp_eq_u32 s4, 0
s_cselect_b32 s56, s56, s57
s_lshl_b32 s56, s56, 2
s_add_u32 s56, s56, s14
s_lshl_b32 s15, s56, 7
s_load_dword s54, s[40:41], s7
s_load_dword s54, s[40:41], s15
v_lshrrev_b32 v3, 5, v1
v_bfe_u32 v4, v1, 2, 2
v_lshl_add_u32 v4, v3, 2, v4
v_lshlrev_b32_e64 v4, 7, v4
v_bfe_u32 v5, v1, 3, 1
v_lshl_add_u32 v4, v5, 6, v4
v_bfe_u32 v5, v1, 4, 1
v_lshl_add_u32 v4, v5, 5, v4
v_and_b32_e64 v5, 3, v1
v_lshl_add_u32 v211, v5, 3, v4
s_and_b32 s56, s14, 2
s_lshl_b32 s57, s56, 5
v_xor_b32 v211, s57, v211
v_lshrrev_b32 v4, 2, v1
v_bfe_u32 v5, v1, 3, 2
v_and_b32 v2, 3, v1
v_xor_b32 v5, v5, v2
v_lshlrev_b32_e64 v5, 4, v5
v_lshl_add_u32 v212, v4, 11, v5
v_and_b32 v2, 31, v1
v_and_b32 v209, 15, v1
v_lshlrev_b32_e64 v209, 4, v209
v_lshl_add_u32 v209, v3, 8, v209
v_lshlrev_b32 v208, 4, v1
v_lshlrev_b32 v3, 2, v3
v_sub_u32 v2, v2, v3
s_lshl_b32 s56, s3, 3
v_subrev_u32 v2, s56, v2
s_cmp_eq_u32 s4, 0
s_cselect_b32 s56, 0xfffffff1, 0x80000000
s_cselect_b32 s57, 0, -1
s_cselect_b32 s58, 32, 0
s_mov_b32 s59, 0xe0ad78ec
v_mov_b32 v3, s58
v_subrev_u32 v240, 0, v2
v_and_b32_e64 v224, s56, v240
v_xad_u32 v240, v240, s57, v3
v_cvt_f32_u32 v224, v224
v_and_b32 v240, s56, v240
v_mul_f32 v224, s59, v224
v_cvt_f32_u32 v240, v240
v_mul_f32 v240, s59, v240
v_subrev_u32 v241, 1, v2
v_and_b32_e64 v225, s56, v241
v_xad_u32 v241, v241, s57, v3
v_cvt_f32_u32 v225, v225
v_and_b32 v241, s56, v241
v_mul_f32 v225, s59, v225
v_cvt_f32_u32 v241, v241
v_mul_f32 v241, s59, v241
v_subrev_u32 v242, 2, v2
v_and_b32_e64 v226, s56, v242
v_xad_u32 v242, v242, s57, v3
v_cvt_f32_u32 v226, v226
v_and_b32 v242, s56, v242
v_mul_f32 v226, s59, v226
v_cvt_f32_u32 v242, v242
v_mul_f32 v242, s59, v242
v_subrev_u32 v243, 3, v2
v_and_b32_e64 v227, s56, v243
v_xad_u32 v243, v243, s57, v3
v_cvt_f32_u32 v227, v227
v_and_b32 v243, s56, v243
v_mul_f32 v227, s59, v227
v_cvt_f32_u32 v243, v243
v_mul_f32 v243, s59, v243
v_lshrrev_b32 v2, 3, v1
v_and_b32_e64 v3, 7, v1
v_bfe_u32 v210, v1, 4, 1
v_lshlrev_b32 v210, 2, v210
v_xor_b32 v3, v3, v210
v_lshlrev_b32_e64 v3, 4, v3
v_lshl_add_u32 v210, v2, 10, v3
v_add_u32 v85, 151552, v208
s_lshl_b32 s56, s3, 10
v_add_u32 v2, s56, v85
ds_write_b128 v2, v[224:227] offset:2048
ds_write_b128 v2, v[240:243] offset:6144
s_cmp_lg_u32 s3, 0
s_cbranch_scc1 L_nocw
ds_write_b128 v2, v[208:211]
L_nocw:
v_and_b32 v2, 15, v1
v_lshrrev_b32 v3, 4, v1
v_bfe_u32 v12, v1, 1, 3
v_xor_b32 v12, v12, v3
v_lshlrev_b32 v12, 4, v12
s_sub_u32 s56, 13, s4
s_lshl_b32 s56, s60, s56
s_add_u32 s56, s56, 24576
v_lshl_add_u32 v12, v2, 7, v12
v_add_u32 v4, s56, v12
v_xor_b32 v5, 64, v4
v_bfe_u32 v12, v1, 2, 2
v_lshl_add_u32 v12, v3, 3, v12
v_lshlrev_b32_e64 v12, 7, v12
v_bfe_u32 v13, v1, 3, 1
v_xor_b32_e64 v13, s61, v13
v_lshl_add_u32 v12, v13, 6, v12
v_and_b32_e64 v13, 1, v3
v_lshl_add_u32 v12, v13, 5, v12
v_and_b32_e64 v13, 3, v1
v_lshl_add_u32 v6, v13, 3, v12
v_xor_b32 v7, 32, v6
v_lshrrev_b32 v3, 5, v1
v_and_b32 v2, 31, v1
v_lshlrev_b32 v2, 4, v2
v_lshl_add_u32 v213, v3, 16, v2
v_mul_u32_u24 v3, 12288, v3
s_mul_i32 s56, s61, 24576
s_lshl_b32 s57, s60, 10
s_add_u32 s56, s56, s57
v_add_u32_e64 v83, s56, v208
v_add_u32 v81, 8192, v83
s_add_u32 s56, s56, 57344
v_add3_u32 v82, v3, v2, s56
s_mul_i32 s56, s61, 6144
s_add_u32 s56, s56, 65536
v_add_u32_e64 v84, s56, v208
s_lshl_b32 s56, s6, 2
s_lshl_b32 s57, s61, 1
s_add_u32 s56, s56, s57
s_lshl_b32 s57, s5, 2
s_lshl_b32 s58, s60, 1
s_add_u32 s57, s57, s58
s_lshl_b32 s58, s56, 6
s_add_u32 s58, s58, s57
s_sub_u32 s58, s58, s60
s_lshl_b32 s58, s58, 10
s_add_u32 s64, s58, 2097152
s_add_u32 s65, s58, 2162688
s_add_u32 s66, s58, 4194304
s_lshl_b32 s58, s57, 5
s_add_u32 s58, s58, s56
s_lshl_b32 s58, s58, 10
s_add_u32 s70, s58, 6291456
s_add_u32 s71, s70, 32768
s_mov_b32 s52, 0x3eb8aa3b
s_mov_b32 s53, s52
s_mov_b32 s48, 0x3f803f80
s_mov_b32 s49, s48
s_lshl_b32 s69, s5, 3
s_add_u32 s69, s69, s6
s_lshl_b32 s69, s69, 1
s_add_u32 s69, s69, s61
s_lshl_b32 s69, s69, 5
s_add_u32 s69, s69, s60
s_lshl_b32 s69, s69, 3
s_add_u32 s69, s69, 8192
v_and_b32 v2, 1, v1
v_lshlrev_b32 v2, 7, v2
v_lshrrev_b32_e64 v3, 1, v1
v_mul_u32_u24 v3, 4112, v3
v_add_u32 v214, v2, v3
s_cmp_eq_u32 s4, 0
s_cselect_b32 s56, 0, s48
s_mov_b32 s57, s56
v_mov_b64 v[192:193], s[56:57]
v_mov_b64 v[194:195], s[56:57]
v_mov_b64 v[196:197], s[56:57]
v_mov_b64 v[198:199], s[56:57]
v_mov_b64 v[200:201], s[56:57]
v_mov_b64 v[202:203], s[56:57]
v_mov_b64 v[204:205], s[56:57]
v_mov_b64 v[206:207], s[56:57]
s_cmp_lg_u32 s4, 0
s_cbranch_scc1 L_gB
s_cmp_lg_u32 s60, 0
s_cbranch_scc1 L_gA1
s_mov_b32 s62, 0
s_mov_b32 s63, 0
v_add_u32 v8, s62, v4
v_add_u32 v10, s62, v6
v_add_u32 v11, s62, v7
v_add_u32_e64 v9, s62, v5
s_waitcnt lgkmcnt(0)
s_mul_i32 s10, s10, 0x9e3779b1
s_add_u32 s10, s10, 0x7f4a7c15
s_mul_i32 s11, s11, 0x2c9277b5
s_add_u32 s11, s11, 0xac564b05
s_xor_b32 s11, s11, s10
s_barrier
s_barrier
s_cmp_lg_u32 s3, 0
s_cbranch_scc1 L_nst
s_lshl_b32 s56, s2, 2
s_add_u32 s56, s56, 1024
v_mov_b32 v2, s10
v_mov_b32_e64 v3, s11
s_mov_b64 exec, 1
buffer_store_dwordx2 v[2:3], off, s[40:43], s56 sc1
s_mov_b64 exec, -1
L_nst:
s_barrier
s_barrier
s_nop 0
ds_read_b128 v[40:43], v8 offset:0
ds_read_b64_tr_b16 v[16:17], v10 offset:8192
ds_read_b64_tr_b16 v[18:19], v10 offset:8704
ds_read_b128 v[44:47], v8 offset:2048
ds_read_b128 v[48:51], v8 offset:4096
ds_read_b128 v[52:55], v8 offset:6144
ds_read_b128 v[56:59], v8 offset:16384
ds_read_b64_tr_b16 v[20:21], v11 offset:8192
ds_read_b64_tr_b16 v[22:23], v11 offset:8704
s_waitcnt lgkmcnt(6)
v_mfma_f32_16x16x32_bf16 v[128:131], v[16:19], v[40:43], v[128:131]
ds_read_b64_tr_b16 v[24:25], v10 offset:16384
ds_read_b64_tr_b16 v[26:27], v10 offset:16896
s_waitcnt lgkmcnt(7)
v_mfma_f32_16x16x32_bf16 v[132:135], v[16:19], v[44:47], v[132:135]
ds_read_b64_tr_b16 v[28:29], v11 offset:16384
ds_read_b64_tr_b16 v[30:31], v11 offset:16896
s_waitcnt lgkmcnt(8)
v_mfma_f32_16x16x32_bf16 v[136:139], v[16:19], v[48:51], v[136:139]
ds_read_b64_tr_b16 v[32:33], v10 offset:0
ds_read_b64_tr_b16 v[34:35], v10 offset:512
s_waitcnt lgkmcnt(9)
v_mfma_f32_16x16x32_bf16 v[140:143], v[16:19], v[52:55], v[140:143]
ds_read_b64_tr_b16 v[36:37], v11 offset:0
ds_read_b64_tr_b16 v[38:39], v11 offset:512
s_waitcnt lgkmcnt(10)
v_mfma_f32_16x16x32_bf16 v[192:195], v[16:19], v[56:59], v[192:195]
ds_read_b128 v[224:227], v85 offset:2048
ds_read_b128 v[228:231], v85 offset:3072
s_waitcnt lgkmcnt(10)
v_mfma_f32_16x16x32_bf16 v[144:147], v[20:23], v[40:43], v[144:147]
ds_read_b128 v[232:235], v85 offset:4096
ds_read_b128 v[236:239], v85 offset:5120
v_mfma_f32_16x16x32_bf16 v[148:151], v[20:23], v[44:47], v[148:151]
ds_read_b128 v[240:243], v85 offset:6144
ds_read_b128 v[244:247], v85 offset:7168
v_mfma_f32_16x16x32_bf16 v[152:155], v[20:23], v[48:51], v[152:155]
ds_read_b128 v[248:251], v85 offset:8192
ds_read_b128 v[252:255], v85 offset:9216
v_mfma_f32_16x16x32_bf16 v[156:159], v[20:23], v[52:55], v[156:159]
v_mfma_f32_16x16x32_bf16 v[196:199], v[20:23], v[56:59], v[196:199]
s_waitcnt lgkmcnt(8)
L_g_a0:
v_mfma_f32_16x16x32_bf16 v[160:163], v[40:43], v[24:27], v[160:163]
ds_read_b128 v[60:63], v9 offset:0
v_mfma_f32_16x16x32_bf16 v[168:171], v[44:47], v[24:27], v[168:171]
ds_read_b64_tr_b16 v[16:17], v10 offset:12288
v_mfma_f32_16x16x32_bf16 v[176:179], v[48:51], v[24:27], v[176:179]
ds_read_b64_tr_b16 v[18:19], v10 offset:12800
v_mfma_f32_16x16x32_bf16 v[184:187], v[52:55], v[24:27], v[184:187]
ds_read_b128 v[64:67], v9 offset:2048
v_mfma_f32_16x16x32_bf16 v[164:167], v[40:43], v[28:31], v[164:167]
ds_read_b128 v[68:71], v9 offset:4096
v_mfma_f32_16x16x32_bf16 v[172:175], v[44:47], v[28:31], v[172:175]
ds_read_b128 v[72:75], v9 offset:6144
v_mfma_f32_16x16x32_bf16 v[180:183], v[48:51], v[28:31], v[180:183]
ds_read_b128 v[76:79], v9 offset:16384
v_mfma_f32_16x16x32_bf16 v[188:191], v[52:55], v[28:31], v[188:191]
ds_read_b64_tr_b16 v[20:21], v11 offset:12288
v_mfma_f32_16x16x32_bf16 v[96:99], v[32:35], v[40:43], v[96:99]
ds_read_b64_tr_b16 v[22:23], v11 offset:12800
v_mfma_f32_16x16x32_bf16 v[100:103], v[32:35], v[44:47], v[100:103]
ds_read_b64_tr_b16 v[24:25], v10 offset:20480
v_mfma_f32_16x16x32_bf16 v[104:107], v[32:35], v[48:51], v[104:107]
ds_read_b64_tr_b16 v[26:27], v10 offset:20992
v_mfma_f32_16x16x32_bf16 v[108:111], v[32:35], v[52:55], v[108:111]
ds_read_b64_tr_b16 v[28:29], v11 offset:20480
v_mfma_f32_16x16x32_bf16 v[112:115], v[36:39], v[40:43], v[112:115]
ds_read_b64_tr_b16 v[30:31], v11 offset:20992
v_mfma_f32_16x16x32_bf16 v[116:119], v[36:39], v[44:47], v[116:119]
ds_read_b64_tr_b16 v[32:33], v10 offset:4096
v_mfma_f32_16x16x32_bf16 v[120:123], v[36:39], v[48:51], v[120:123]
ds_read_b64_tr_b16 v[34:35], v10 offset:4608
v_mfma_f32_16x16x32_bf16 v[124:127], v[36:39], v[52:55], v[124:127]
s_waitcnt lgkmcnt(6)
v_mfma_f32_16x16x32_bf16 v[128:131], v[16:19], v[60:63], v[128:131]
ds_read_b64_tr_b16 v[36:37], v11 offset:4096
v_mfma_f32_16x16x32_bf16 v[132:135], v[16:19], v[64:67], v[132:135]
ds_read_b64_tr_b16 v[38:39], v11 offset:4608
v_mfma_f32_16x16x32_bf16 v[136:139], v[16:19], v[68:71], v[136:139]
s_add_u32 s62, s62, 43008
s_cmp_ge_u32 s62, 129024
v_mfma_f32_16x16x32_bf16 v[140:143], v[16:19], v[72:75], v[140:143]
s_cselect_b32 s62, 0, s62
s_add_u32 s63, s63, 1
v_mfma_f32_16x16x32_bf16 v[192:195], v[16:19], v[76:79], v[192:195]
v_add_u32 v8, s62, v4
s_cmp_eq_u32 s63, 8
v_mfma_f32_16x16x32_bf16 v[144:147], v[20:23], v[60:63], v[144:147]
v_add_u32_e64 v10, s62, v6
v_mfma_f32_16x16x32_bf16 v[148:151], v[20:23], v[64:67], v[148:151]
v_add_u32 v11, s62, v7
v_add_u32 v9, s62, v5
v_mfma_f32_16x16x32_bf16 v[152:155], v[20:23], v[68:71], v[152:155]
v_mfma_f32_16x16x32_bf16 v[156:159], v[20:23], v[72:75], v[156:159]
v_mfma_f32_16x16x32_bf16 v[196:199], v[20:23], v[76:79], v[196:199]
s_waitcnt lgkmcnt(0)
s_barrier
v_mfma_f32_16x16x32_bf16 v[160:163], v[60:63], v[24:27], v[160:163]
s_cbranch_scc1 L_gx_a0
ds_read_b128 v[40:43], v8 offset:0
v_mfma_f32_16x16x32_bf16 v[168:171], v[64:67], v[24:27], v[168:171]
ds_read_b64_tr_b16 v[16:17], v10 offset:8192
v_mfma_f32_16x16x32_bf16 v[176:179], v[68:71], v[24:27], v[176:179]
ds_read_b64_tr_b16 v[18:19], v10 offset:8704
v_mfma_f32_16x16x32_bf16 v[184:187], v[72:75], v[24:27], v[184:187]
ds_read_b128 v[44:47], v8 offset:2048
v_mfma_f32_16x16x32_bf16 v[164:167], v[60:63], v[28:31], v[164:167]
ds_read_b128 v[48:51], v8 offset:4096
v_mfma_f32_16x16x32_bf16 v[172:175], v[64:67], v[28:31], v[172:175]
ds_read_b128 v[52:55], v8 offset:6144
v_mfma_f32_16x16x32_bf16 v[180:183], v[68:71], v[28:31], v[180:183]
ds_read_b128 v[56:59], v8 offset:16384
v_mfma_f32_16x16x32_bf16 v[188:191], v[72:75], v[28:31], v[188:191]
ds_read_b64_tr_b16 v[20:21], v11 offset:8192
v_mfma_f32_16x16x32_bf16 v[96:99], v[32:35], v[60:63], v[96:99]
ds_read_b64_tr_b16 v[22:23], v11 offset:8704
v_mfma_f32_16x16x32_bf16 v[100:103], v[32:35], v[64:67], v[100:103]
ds_read_b64_tr_b16 v[24:25], v10 offset:16384
v_mfma_f32_16x16x32_bf16 v[104:107], v[32:35], v[68:71], v[104:107]
ds_read_b64_tr_b16 v[26:27], v10 offset:16896
v_mfma_f32_16x16x32_bf16 v[108:111], v[32:35], v[72:75], v[108:111]
ds_read_b64_tr_b16 v[28:29], v11 offset:16384
v_mfma_f32_16x16x32_bf16 v[112:115], v[36:39], v[60:63], v[112:115]
ds_read_b64_tr_b16 v[30:31], v11 offset:16896
v_mfma_f32_16x16x32_bf16 v[116:119], v[36:39], v[64:67], v[116:119]
ds_read_b64_tr_b16 v[32:33], v10 offset:0
v_mfma_f32_16x16x32_bf16 v[120:123], v[36:39], v[68:71], v[120:123]
ds_read_b64_tr_b16 v[34:35], v10 offset:512
v_mfma_f32_16x16x32_bf16 v[124:127], v[36:39], v[72:75], v[124:127]
s_waitcnt lgkmcnt(6)
v_mfma_f32_16x16x32_bf16 v[128:131], v[16:19], v[40:43], v[128:131]
ds_read_b64_tr_b16 v[36:37], v11 offset:0
v_mfma_f32_16x16x32_bf16 v[132:135], v[16:19], v[44:47], v[132:135]
ds_read_b64_tr_b16 v[38:39], v11 offset:512
v_mfma_f32_16x16x32_bf16 v[136:139], v[16:19], v[48:51], v[136:139]
v_mfma_f32_16x16x32_bf16 v[140:143], v[16:19], v[52:55], v[140:143]
v_mfma_f32_16x16x32_bf16 v[192:195], v[16:19], v[56:59], v[192:195]
v_mfma_f32_16x16x32_bf16 v[144:147], v[20:23], v[40:43], v[144:147]
v_mfma_f32_16x16x32_bf16 v[148:151], v[20:23], v[44:47], v[148:151]
v_mfma_f32_16x16x32_bf16 v[152:155], v[20:23], v[48:51], v[152:155]
v_mfma_f32_16x16x32_bf16 v[156:159], v[20:23], v[52:55], v[156:159]
v_mfma_f32_16x16x32_bf16 v[196:199], v[20:23], v[56:59], v[196:199]
s_waitcnt lgkmcnt(0)
s_branch L_g_a0
L_gx_a0:
v_mfma_f32_16x16x32_bf16 v[168:171], v[64:67], v[24:27], v[168:171]
v_mfma_f32_16x16x32_bf16 v[176:179], v[68:71], v[24:27], v[176:179]
v_mfma_f32_16x16x32_bf16 v[184:187], v[72:75], v[24:27], v[184:187]
v_mfma_f32_16x16x32_bf16 v[164:167], v[60:63], v[28:31], v[164:167]
v_mfma_f32_16x16x32_bf16 v[172:175], v[64:67], v[28:31], v[172:175]
v_mfma_f32_16x16x32_bf16 v[180:183], v[68:71], v[28:31], v[180:183]
v_mfma_f32_16x16x32_bf16 v[188:191], v[72:75], v[28:31], v[188:191]
v_mfma_f32_16x16x32_bf16 v[96:99], v[32:35], v[60:63], v[96:99]
v_mfma_f32_16x16x32_bf16 v[100:103], v[32:35], v[64:67], v[100:103]
v_mfma_f32_16x16x32_bf16 v[104:107], v[32:35], v[68:71], v[104:107]
v_mfma_f32_16x16x32_bf16 v[108:111], v[32:35], v[72:75], v[108:111]
v_mfma_f32_16x16x32_bf16 v[112:115], v[36:39], v[60:63], v[112:115]
v_mfma_f32_16x16x32_bf16 v[116:119], v[36:39], v[64:67], v[116:119]
v_mfma_f32_16x16x32_bf16 v[120:123], v[36:39], v[68:71], v[120:123]
v_mfma_f32_16x16x32_bf16 v[124:127], v[36:39], v[72:75], v[124:127]
v_cvt_pk_bf16_f32 v128, v128, v129
v_cvt_pk_bf16_f32 v129, v130, v131
v_cvt_pk_bf16_f32 v130, v132, v133
v_cvt_pk_bf16_f32 v131, v134, v135
v_cvt_pk_bf16_f32 v132, v136, v137
v_cvt_pk_bf16_f32 v133, v138, v139
v_cvt_pk_bf16_f32 v134, v140, v141
v_cvt_pk_bf16_f32 v135, v142, v143
v_cvt_pk_bf16_f32 v136, v144, v145
v_cvt_pk_bf16_f32 v137, v146, v147
v_cvt_pk_bf16_f32 v138, v148, v149
v_cvt_pk_bf16_f32 v139, v150, v151
v_cvt_pk_bf16_f32 v140, v152, v153
v_cvt_pk_bf16_f32 v141, v154, v155
v_cvt_pk_bf16_f32 v142, v156, v157
v_cvt_pk_bf16_f32 v143, v158, v159
v_permlane16_swap_b32 v128, v130
v_permlane16_swap_b32 v129, v131
v_permlane16_swap_b32 v132, v134
v_permlane16_swap_b32 v133, v135
v_permlane16_swap_b32 v136, v138
v_permlane16_swap_b32 v137, v139
v_permlane16_swap_b32 v140, v142
v_permlane16_swap_b32 v141, v143
v_cvt_pk_bf16_f32 v184, v184, v185
v_cvt_pk_bf16_f32 v185, v186, v187
v_mov_b64_e64 v[186:187], s[48:49]
v_cvt_pk_bf16_f32 v188, v188, v189
v_cvt_pk_bf16_f32 v189, v190, v191
v_mov_b64 v[190:191], s[48:49]
v_permlane16_swap_b32 v184, v186
v_permlane16_swap_b32 v185, v187
v_permlane16_swap_b32 v188, v190
v_permlane16_swap_b32 v189, v191
v_permlane32_swap_b32 v184, v186
v_permlane32_swap_b32 v185, v187
v_permlane32_swap_b32 v188, v190
v_permlane32_swap_b32_e64 v189, v191
ds_write_b128 v84, v[132:135]
ds_write_b128 v84, v[140:143] offset:1024
ds_write_b128 v84, v[184:187] offset:2048
ds_write_b128 v84, v[188:191] offset:3072
v_cvt_pk_bf16_f32 v96, v96, v97
v_cvt_pk_bf16_f32 v97, v98, v99
v_cvt_pk_bf16_f32 v98, v100, v101
v_cvt_pk_bf16_f32 v99, v102, v103
v_cvt_pk_bf16_f32 v100, v104, v105
v_cvt_pk_bf16_f32 v101, v106, v107
v_cvt_pk_bf16_f32 v102, v108, v109
v_cvt_pk_bf16_f32 v103, v110, v111
v_cvt_pk_bf16_f32 v104, v112, v113
v_cvt_pk_bf16_f32 v105, v114, v115
v_cvt_pk_bf16_f32 v106, v116, v117
v_cvt_pk_bf16_f32 v107, v118, v119
v_cvt_pk_bf16_f32 v108, v120, v121
v_cvt_pk_bf16_f32 v109, v122, v123
v_cvt_pk_bf16_f32 v110, v124, v125
v_cvt_pk_bf16_f32 v111, v126, v127
v_permlane16_swap_b32 v96, v98
v_permlane16_swap_b32 v97, v99
v_permlane16_swap_b32 v100, v102
v_permlane16_swap_b32 v101, v103
v_permlane16_swap_b32 v104, v106
v_permlane16_swap_b32 v105, v107
v_permlane16_swap_b32 v108, v110
v_permlane16_swap_b32 v109, v111
v_cvt_pk_bf16_f32 v112, v192, v193
v_cvt_pk_bf16_f32 v113, v194, v195
v_cvt_pk_bf16_f32 v114, v192, v193
v_cvt_pk_bf16_f32 v115, v194, v195
v_cvt_pk_bf16_f32 v116, v196, v197
v_cvt_pk_bf16_f32 v117, v198, v199
v_cvt_pk_bf16_f32 v118, v196, v197
v_cvt_pk_bf16_f32 v119, v198, v199
v_permlane16_swap_b32 v112, v114
v_permlane16_swap_b32 v113, v115
v_permlane16_swap_b32 v116, v118
v_permlane16_swap_b32 v117, v119
s_waitcnt lgkmcnt(0)
s_barrier
ds_read_b128 v[120:123], v84 offset:4096
ds_read_b128 v[124:127], v84 offset:5120
s_branch L_attA
L_gA1:
s_mov_b32 s62, 0
s_mov_b32 s63, 0
v_add_u32 v8, s62, v4
v_add_u32 v10, s62, v6
v_add_u32 v11, s62, v7
v_add_u32 v9, s62, v5
s_waitcnt lgkmcnt(0)
s_mul_i32 s10, s10, 0x9e3779b1
s_add_u32 s10, s10, 0x7f4a7c15
s_mul_i32 s11, s11, 0x2c9277b5
s_add_u32 s11, s11, 0xac564b05
s_xor_b32 s11, s11, s10
s_barrier
s_barrier
s_barrier
s_barrier
s_nop 0
ds_read_b128 v[40:43], v8 offset:0
ds_read_b64_tr_b16 v[16:17], v10 offset:8192
ds_read_b64_tr_b16 v[18:19], v10 offset:8704
ds_read_b128 v[44:47], v8 offset:2048
ds_read_b128 v[48:51], v8 offset:4096
ds_read_b128 v[52:55], v8 offset:6144
ds_read_b128 v[56:59], v8 offset:8192
ds_read_b64_tr_b16 v[20:21], v11 offset:8192
ds_read_b64_tr_b16 v[22:23], v11 offset:8704
s_waitcnt lgkmcnt(6)
v_mfma_f32_16x16x32_bf16 v[128:131], v[16:19], v[40:43], v[128:131]
ds_read_b64_tr_b16 v[24:25], v10 offset:16384
ds_read_b64_tr_b16 v[26:27], v10 offset:16896
s_waitcnt lgkmcnt(7)
v_mfma_f32_16x16x32_bf16 v[132:135], v[16:19], v[44:47], v[132:135]
ds_read_b64_tr_b16 v[28:29], v11 offset:16384
ds_read_b64_tr_b16 v[30:31], v11 offset:16896
s_waitcnt lgkmcnt(8)
v_mfma_f32_16x16x32_bf16 v[136:139], v[16:19], v[48:51], v[136:139]
ds_read_b64_tr_b16 v[32:33], v10 offset:0
ds_read_b64_tr_b16 v[34:35], v10 offset:512
s_waitcnt lgkmcnt(9)
v_mfma_f32_16x16x32_bf16 v[140:143], v[16:19], v[52:55], v[140:143]
ds_read_b64_tr_b16 v[36:37], v11 offset:0
ds_read_b64_tr_b16 v[38:39], v11 offset:512
s_waitcnt lgkmcnt(8)
v_mfma_f32_16x16x32_bf16 v[144:147], v[20:23], v[40:43], v[144:147]
ds_read_b128 v[224:227], v85 offset:2048
ds_read_b128 v[228:231], v85 offset:3072
v_mfma_f32_16x16x32_bf16 v[148:151], v[20:23], v[44:47], v[148:151]
ds_read_b128 v[232:235], v85 offset:4096
ds_read_b128 v[236:239], v85 offset:5120
v_mfma_f32_16x16x32_bf16 v[152:155], v[20:23], v[48:51], v[152:155]
ds_read_b128 v[240:243], v85 offset:6144
ds_read_b128 v[244:247], v85 offset:7168
v_mfma_f32_16x16x32_bf16 v[156:159], v[20:23], v[52:55], v[156:159]
ds_read_b128 v[248:251], v85 offset:8192
ds_read_b128 v[252:255], v85 offset:9216
s_waitcnt lgkmcnt(8)
L_g_a1:
v_mfma_f32_16x16x32_bf16 v[160:163], v[40:43], v[24:27], v[160:163]
ds_read_b128 v[60:63], v9 offset:0
v_mfma_f32_16x16x32_bf16 v[168:171], v[44:47], v[24:27], v[168:171]
ds_read_b64_tr_b16 v[16:17], v10 offset:12288
v_mfma_f32_16x16x32_bf16 v[176:179], v[48:51], v[24:27], v[176:179]
ds_read_b64_tr_b16 v[18:19], v10 offset:12800
v_mfma_f32_16x16x32_bf16 v[184:187], v[52:55], v[24:27], v[184:187]
ds_read_b128 v[64:67], v9 offset:2048
v_mfma_f32_16x16x32_bf16 v[192:195], v[56:59], v[24:27], v[192:195]
ds_read_b128 v[68:71], v9 offset:4096
v_mfma_f32_16x16x32_bf16 v[164:167], v[40:43], v[28:31], v[164:167]
ds_read_b128 v[72:75], v9 offset:6144
v_mfma_f32_16x16x32_bf16 v[172:175], v[44:47], v[28:31], v[172:175]
ds_read_b128 v[76:79], v9 offset:8192
v_mfma_f32_16x16x32_bf16 v[180:183], v[48:51], v[28:31], v[180:183]
ds_read_b64_tr_b16 v[20:21], v11 offset:12288
v_mfma_f32_16x16x32_bf16 v[188:191], v[52:55], v[28:31], v[188:191]
ds_read_b64_tr_b16 v[22:23], v11 offset:12800
v_mfma_f32_16x16x32_bf16 v[196:199], v[56:59], v[28:31], v[196:199]
v_mfma_f32_16x16x32_bf16 v[96:99], v[32:35], v[40:43], v[96:99]
ds_read_b64_tr_b16 v[24:25], v10 offset:20480
v_mfma_f32_16x16x32_bf16 v[100:103], v[32:35], v[44:47], v[100:103]
ds_read_b64_tr_b16 v[26:27], v10 offset:20992
v_mfma_f32_16x16x32_bf16 v[104:107], v[32:35], v[48:51], v[104:107]
ds_read_b64_tr_b16 v[28:29], v11 offset:20480
v_mfma_f32_16x16x32_bf16 v[108:111], v[32:35], v[52:55], v[108:111]
ds_read_b64_tr_b16 v[30:31], v11 offset:20992
v_mfma_f32_16x16x32_bf16 v[112:115], v[36:39], v[40:43], v[112:115]
ds_read_b64_tr_b16 v[32:33], v10 offset:4096
v_mfma_f32_16x16x32_bf16 v[116:119], v[36:39], v[44:47], v[116:119]
ds_read_b64_tr_b16 v[34:35], v10 offset:4608
v_mfma_f32_16x16x32_bf16 v[120:123], v[36:39], v[48:51], v[120:123]
v_mfma_f32_16x16x32_bf16 v[124:127], v[36:39], v[52:55], v[124:127]
s_waitcnt lgkmcnt(6)
v_mfma_f32_16x16x32_bf16 v[128:131], v[16:19], v[60:63], v[128:131]
ds_read_b64_tr_b16 v[36:37], v11 offset:4096
v_mfma_f32_16x16x32_bf16 v[132:135], v[16:19], v[64:67], v[132:135]
ds_read_b64_tr_b16 v[38:39], v11 offset:4608
v_mfma_f32_16x16x32_bf16 v[136:139], v[16:19], v[68:71], v[136:139]
s_add_u32 s62, s62, 43008
s_cmp_ge_u32 s62, 129024
v_mfma_f32_16x16x32_bf16 v[140:143], v[16:19], v[72:75], v[140:143]
s_cselect_b32 s62, 0, s62
s_add_u32 s63, s63, 1
v_mfma_f32_16x16x32_bf16 v[144:147], v[20:23], v[60:63], v[144:147]
v_add_u32_e64 v8, s62, v4
s_cmp_eq_u32 s63, 8
v_mfma_f32_16x16x32_bf16 v[148:151], v[20:23], v[64:67], v[148:151]
v_add_u32_e64 v10, s62, v6
v_mfma_f32_16x16x32_bf16 v[152:155], v[20:23], v[68:71], v[152:155]
v_add_u32 v11, s62, v7
v_add_u32 v9, s62, v5
v_mfma_f32_16x16x32_bf16 v[156:159], v[20:23], v[72:75], v[156:159]
s_waitcnt lgkmcnt(0)
s_barrier
v_mfma_f32_16x16x32_bf16 v[160:163], v[60:63], v[24:27], v[160:163]
s_cbranch_scc1 L_gx_a1
ds_read_b128 v[40:43], v8 offset:0
v_mfma_f32_16x16x32_bf16 v[168:171], v[64:67], v[24:27], v[168:171]
ds_read_b64_tr_b16 v[16:17], v10 offset:8192
v_mfma_f32_16x16x32_bf16 v[176:179], v[68:71], v[24:27], v[176:179]
ds_read_b64_tr_b16 v[18:19], v10 offset:8704
v_mfma_f32_16x16x32_bf16 v[184:187], v[72:75], v[24:27], v[184:187]
ds_read_b128 v[44:47], v8 offset:2048
v_mfma_f32_16x16x32_bf16 v[192:195], v[76:79], v[24:27], v[192:195]
ds_read_b128 v[48:51], v8 offset:4096
v_mfma_f32_16x16x32_bf16 v[164:167], v[60:63], v[28:31], v[164:167]
ds_read_b128 v[52:55], v8 offset:6144
v_mfma_f32_16x16x32_bf16 v[172:175], v[64:67], v[28:31], v[172:175]
ds_read_b128 v[56:59], v8 offset:8192
v_mfma_f32_16x16x32_bf16 v[180:183], v[68:71], v[28:31], v[180:183]
ds_read_b64_tr_b16 v[20:21], v11 offset:8192
v_mfma_f32_16x16x32_bf16 v[188:191], v[72:75], v[28:31], v[188:191]
ds_read_b64_tr_b16 v[22:23], v11 offset:8704
v_mfma_f32_16x16x32_bf16 v[196:199], v[76:79], v[28:31], v[196:199]
v_mfma_f32_16x16x32_bf16 v[96:99], v[32:35], v[60:63], v[96:99]
ds_read_b64_tr_b16 v[24:25], v10 offset:16384
v_mfma_f32_16x16x32_bf16 v[100:103], v[32:35], v[64:67], v[100:103]
ds_read_b64_tr_b16 v[26:27], v10 offset:16896
v_mfma_f32_16x16x32_bf16 v[104:107], v[32:35], v[68:71], v[104:107]
ds_read_b64_tr_b16 v[28:29], v11 offset:16384
v_mfma_f32_16x16x32_bf16 v[108:111], v[32:35], v[72:75], v[108:111]
ds_read_b64_tr_b16 v[30:31], v11 offset:16896
v_mfma_f32_16x16x32_bf16 v[112:115], v[36:39], v[60:63], v[112:115]
ds_read_b64_tr_b16 v[32:33], v10 offset:0
v_mfma_f32_16x16x32_bf16 v[116:119], v[36:39], v[64:67], v[116:119]
ds_read_b64_tr_b16 v[34:35], v10 offset:512
v_mfma_f32_16x16x32_bf16 v[120:123], v[36:39], v[68:71], v[120:123]
v_mfma_f32_16x16x32_bf16 v[124:127], v[36:39], v[72:75], v[124:127]
s_waitcnt lgkmcnt(6)
v_mfma_f32_16x16x32_bf16 v[128:131], v[16:19], v[40:43], v[128:131]
ds_read_b64_tr_b16 v[36:37], v11 offset:0
v_mfma_f32_16x16x32_bf16 v[132:135], v[16:19], v[44:47], v[132:135]
ds_read_b64_tr_b16 v[38:39], v11 offset:512
v_mfma_f32_16x16x32_bf16 v[136:139], v[16:19], v[48:51], v[136:139]
v_mfma_f32_16x16x32_bf16 v[140:143], v[16:19], v[52:55], v[140:143]
v_mfma_f32_16x16x32_bf16 v[144:147], v[20:23], v[40:43], v[144:147]
v_mfma_f32_16x16x32_bf16 v[148:151], v[20:23], v[44:47], v[148:151]
v_mfma_f32_16x16x32_bf16 v[152:155], v[20:23], v[48:51], v[152:155]
v_mfma_f32_16x16x32_bf16 v[156:159], v[20:23], v[52:55], v[156:159]
s_waitcnt lgkmcnt(0)
s_branch L_g_a1
L_gx_a1:
v_mfma_f32_16x16x32_bf16 v[168:171], v[64:67], v[24:27], v[168:171]
v_mfma_f32_16x16x32_bf16 v[176:179], v[68:71], v[24:27], v[176:179]
v_mfma_f32_16x16x32_bf16 v[184:187], v[72:75], v[24:27], v[184:187]
v_mfma_f32_16x16x32_bf16 v[192:195], v[76:79], v[24:27], v[192:195]
v_mfma_f32_16x16x32_bf16 v[164:167], v[60:63], v[28:31], v[164:167]
v_mfma_f32_16x16x32_bf16 v[172:175], v[64:67], v[28:31], v[172:175]
v_mfma_f32_16x16x32_bf16 v[180:183], v[68:71], v[28:31], v[180:183]
v_mfma_f32_16x16x32_bf16 v[188:191], v[72:75], v[28:31], v[188:191]
v_mfma_f32_16x16x32_bf16 v[196:199], v[76:79], v[28:31], v[196:199]
v_mfma_f32_16x16x32_bf16 v[96:99], v[32:35], v[60:63], v[96:99]
v_mfma_f32_16x16x32_bf16 v[100:103], v[32:35], v[64:67], v[100:103]
v_mfma_f32_16x16x32_bf16 v[104:107], v[32:35], v[68:71], v[104:107]
v_mfma_f32_16x16x32_bf16 v[108:111], v[32:35], v[72:75], v[108:111]
v_mfma_f32_16x16x32_bf16 v[112:115], v[36:39], v[60:63], v[112:115]
v_mfma_f32_16x16x32_bf16 v[116:119], v[36:39], v[64:67], v[116:119]
v_mfma_f32_16x16x32_bf16 v[120:123], v[36:39], v[68:71], v[120:123]
v_mfma_f32_16x16x32_bf16 v[124:127], v[36:39], v[72:75], v[124:127]
v_cvt_pk_bf16_f32 v192, v192, v193
v_cvt_pk_bf16_f32 v193, v194, v195
v_mov_b64_e64 v[194:195], s[48:49]
v_cvt_pk_bf16_f32 v196, v196, v197
v_cvt_pk_bf16_f32 v197, v198, v199
v_mov_b64 v[198:199], s[48:49]
v_permlane16_swap_b32 v192, v194
v_permlane16_swap_b32 v193, v195
v_permlane16_swap_b32 v196, v198
v_permlane16_swap_b32 v197, v199
v_permlane32_swap_b32 v192, v194
v_permlane32_swap_b32 v193, v195
v_permlane32_swap_b32 v196, v198
v_permlane32_swap_b32_e64 v197, v199
ds_write_b128 v84, v[192:195] offset:4096
ds_write_b128 v84, v[196:199] offset:5120
v_cvt_pk_bf16_f32 v128, v128, v129
v_cvt_pk_bf16_f32 v129, v130, v131
v_cvt_pk_bf16_f32 v130, v132, v133
v_cvt_pk_bf16_f32 v131, v134, v135
v_cvt_pk_bf16_f32 v132, v136, v137
v_cvt_pk_bf16_f32 v133, v138, v139
v_cvt_pk_bf16_f32 v134, v140, v141
v_cvt_pk_bf16_f32 v135, v142, v143
v_cvt_pk_bf16_f32 v136, v144, v145
v_cvt_pk_bf16_f32 v137, v146, v147
v_cvt_pk_bf16_f32 v138, v148, v149
v_cvt_pk_bf16_f32 v139, v150, v151
v_cvt_pk_bf16_f32 v140, v152, v153
v_cvt_pk_bf16_f32 v141, v154, v155
v_cvt_pk_bf16_f32 v142, v156, v157
v_cvt_pk_bf16_f32 v143, v158, v159
v_permlane16_swap_b32 v128, v130
v_permlane16_swap_b32 v129, v131
v_permlane16_swap_b32 v132, v134
v_permlane16_swap_b32 v133, v135
v_permlane16_swap_b32 v136, v138
v_permlane16_swap_b32 v137, v139
v_permlane16_swap_b32 v140, v142
v_permlane16_swap_b32 v141, v143
v_cvt_pk_bf16_f32 v184, v184, v185
v_cvt_pk_bf16_f32 v185, v186, v187
v_mov_b64_e64 v[186:187], s[48:49]
v_cvt_pk_bf16_f32 v188, v188, v189
v_cvt_pk_bf16_f32 v189, v190, v191
v_mov_b64 v[190:191], s[48:49]
v_permlane16_swap_b32 v184, v186
v_permlane16_swap_b32 v185, v187
v_permlane16_swap_b32 v188, v190
v_permlane16_swap_b32 v189, v191
v_permlane32_swap_b32 v184, v186
v_permlane32_swap_b32 v185, v187
v_permlane32_swap_b32 v188, v190
v_permlane32_swap_b32_e64 v189, v191
v_cvt_pk_bf16_f32 v96, v96, v97
v_cvt_pk_bf16_f32 v97, v98, v99
v_cvt_pk_bf16_f32 v98, v100, v101
v_cvt_pk_bf16_f32 v99, v102, v103
v_cvt_pk_bf16_f32 v100, v104, v105
v_cvt_pk_bf16_f32 v101, v106, v107
v_cvt_pk_bf16_f32 v102, v108, v109
v_cvt_pk_bf16_f32 v103, v110, v111
v_cvt_pk_bf16_f32 v104, v112, v113
v_cvt_pk_bf16_f32 v105, v114, v115
v_cvt_pk_bf16_f32 v106, v116, v117
v_cvt_pk_bf16_f32 v107, v118, v119
v_cvt_pk_bf16_f32 v108, v120, v121
v_cvt_pk_bf16_f32 v109, v122, v123
v_cvt_pk_bf16_f32 v110, v124, v125
v_cvt_pk_bf16_f32 v111, v126, v127
v_permlane16_swap_b32 v96, v98
v_permlane16_swap_b32 v97, v99
v_permlane16_swap_b32 v100, v102
v_permlane16_swap_b32 v101, v103
v_permlane16_swap_b32 v104, v106
v_permlane16_swap_b32 v105, v107
v_permlane16_swap_b32 v108, v110
v_permlane16_swap_b32 v109, v111
s_waitcnt lgkmcnt(0)
s_barrier
ds_read_b128 v[112:115], v84
ds_read_b128 v[116:119], v84 offset:1024
ds_read_b128 v[120:123], v84 offset:2048
ds_read_b128 v[124:127], v84 offset:3072
L_attA:
s_mov_b64 vcc, s[72:73]
v_mfma_f32_32x32x16_bf16 v[16:31], v[132:135], v[100:103], v[224:239]
v_cvt_pk_bf16_f32 v160, v160, v161
v_cvt_pk_bf16_f32 v161, v162, v163
v_mov_b64 v[162:163], s[48:49]
v_cvt_pk_bf16_f32 v164, v164, v165
v_cvt_pk_bf16_f32 v165, v166, v167
v_mov_b64_e64 v[166:167], s[48:49]
v_cvt_pk_bf16_f32 v168, v168, v169
v_cvt_pk_bf16_f32 v169, v170, v171
v_mfma_f32_32x32x16_bf16 v[48:63], v[128:131], v[100:103], v[240:255]
v_mov_b64_e64 v[170:171], s[48:49]
v_cvt_pk_bf16_f32 v172, v172, v173
v_cvt_pk_bf16_f32 v173, v174, v175
v_mov_b64_e64 v[174:175], s[48:49]
v_cvt_pk_bf16_f32 v176, v176, v177
v_cvt_pk_bf16_f32 v177, v178, v179
v_mov_b64_e64 v[178:179], s[48:49]
v_cvt_pk_bf16_f32 v180, v180, v181
v_mfma_f32_32x32x16_bf16 v[32:47], v[140:143], v[108:111], v[224:239]
v_cvt_pk_bf16_f32 v181, v182, v183
v_mov_b64 v[182:183], s[48:49]
v_permlane16_swap_b32 v160, v162
v_permlane16_swap_b32 v161, v163
v_permlane16_swap_b32 v164, v166
v_permlane16_swap_b32 v165, v167
v_permlane16_swap_b32 v168, v170
v_permlane16_swap_b32_e64 v169, v171
v_mfma_f32_32x32x16_bf16 v[64:79], v[136:139], v[108:111], v[240:255]
v_permlane16_swap_b32 v172, v174
v_permlane16_swap_b32 v173, v175
v_permlane16_swap_b32 v176, v178
v_permlane16_swap_b32 v177, v179
v_permlane16_swap_b32 v180, v182
v_permlane16_swap_b32 v181, v183
v_permlane32_swap_b32 v160, v162
v_permlane32_swap_b32 v161, v163
v_permlane32_swap_b32 v164, v166
v_permlane32_swap_b32 v165, v167
v_permlane32_swap_b32 v168, v170
v_permlane32_swap_b32 v169, v171
v_permlane32_swap_b32 v172, v174
v_permlane32_swap_b32 v173, v175
v_permlane32_swap_b32 v176, v178
v_permlane32_swap_b32 v177, v179
v_permlane32_swap_b32 v180, v182
v_permlane32_swap_b32 v181, v183
v_max_f32 v24, v24, v56
v_max_f32 v25, v25, v57
v_max_f32 v26, v26, v58
v_max_f32 v27, v27, v59
v_max_f32 v28, v28, v60
v_max_f32 v29, v29, v61
v_max_f32 v30, v30, v62
v_max_f32 v31, v31, v63
v_max3_f32 v2, v16, v17, v18
v_max3_f32 v3, v19, v20, v21
v_max3_f32 v2, v22, v23, v2
v_max3_f32 v3, v24, v25, v3
v_max3_f32 v2, v26, v27, v2
v_max3_f32 v3, v28, v29, v3
v_max3_f32 v2, v30, v31, v2
v_max_f32 v2, v2, v3
v_mov_b32 v3, v2
s_nop 1
v_permlane32_swap_b32 v2, v3
s_nop 1
v_max_f32 v2, v2, v3
v_mul_f32_e64 v2, s52, v2
v_pk_fma_f32 v[16:17], v[16:17], s[52:53], v[2:3] op_sel_hi:[1,1,0] neg_lo:[0,0,1] neg_hi:[0,0,1]
v_pk_fma_f32 v[18:19], v[18:19], s[52:53], v[2:3] op_sel_hi:[1,1,0] neg_lo:[0,0,1] neg_hi:[0,0,1]
v_pk_fma_f32 v[20:21], v[20:21], s[52:53], v[2:3] op_sel_hi:[1,1,0] neg_lo:[0,0,1] neg_hi:[0,0,1]
v_pk_fma_f32 v[22:23], v[22:23], s[52:53], v[2:3] op_sel_hi:[1,1,0] neg_lo:[0,0,1] neg_hi:[0,0,1]
v_pk_fma_f32 v[24:25], v[24:25], s[52:53], v[2:3] op_sel_hi:[1,1,0] neg_lo:[0,0,1] neg_hi:[0,0,1]
v_pk_fma_f32 v[26:27], v[26:27], s[52:53], v[2:3] op_sel_hi:[1,1,0] neg_lo:[0,0,1] neg_hi:[0,0,1]
v_pk_fma_f32 v[28:29], v[28:29], s[52:53], v[2:3] op_sel_hi:[1,1,0] neg_lo:[0,0,1] neg_hi:[0,0,1]
v_pk_fma_f32 v[30:31], v[30:31], s[52:53], v[2:3] op_sel_hi:[1,1,0] neg_lo:[0,0,1] neg_hi:[0,0,1]
v_exp_f32 v16, v16
v_exp_f32 v17, v17
v_exp_f32 v18, v18
v_exp_f32 v19, v19
v_exp_f32 v20, v20
v_exp_f32 v21, v21
v_exp_f32 v22, v22
v_exp_f32 v23, v23
v_exp_f32 v24, v24
v_exp_f32 v25, v25
v_exp_f32 v26, v26
v_exp_f32 v27, v27
v_exp_f32 v28, v28
v_exp_f32 v29, v29
v_exp_f32 v30, v30
v_exp_f32 v31, v31
v_cvt_pk_bf16_f32 v80, v16, v17
v_cvt_pk_bf16_f32 v81, v18, v19
v_cvt_pk_bf16_f32 v82, v20, v21
v_cvt_pk_bf16_f32 v83, v22, v23
v_cvt_pk_bf16_f32 v84, v24, v25
v_cvt_pk_bf16_f32 v85, v26, v27
v_cvt_pk_bf16_f32 v86, v28, v29
v_cvt_pk_bf16_f32 v87, v30, v31
v_cndmask_b32 v88, 0, v84, vcc
v_cndmask_b32 v89, 0, v85, vcc
v_cndmask_b32 v90, 0, v86, vcc
v_cndmask_b32 v91, 0, v87, vcc
v_xor_b32 v84, v88, v84
v_xor_b32 v85, v89, v85
v_xor_b32 v86, v90, v86
v_xor_b32 v87, v91, v87
v_mfma_f32_32x32x16_bf16 v[192:207], v[176:179], v[80:83], 0
v_max_f32 v40, v40, v72
v_max_f32 v41, v41, v73
v_max_f32 v42, v42, v74
v_max_f32 v43, v43, v75
v_max_f32 v44, v44, v76
v_max_f32 v45, v45, v77
v_max_f32 v46, v46, v78
v_max_f32 v47, v47, v79
v_max3_f32 v2, v32, v33, v34
v_max3_f32 v3, v35, v36, v37
v_mfma_f32_32x32x16_bf16 v[192:207], v[168:171], v[88:91], v[192:207]
v_max3_f32 v2, v38, v39, v2
v_max3_f32 v3, v40, v41, v3
v_max3_f32 v2, v42, v43, v2
v_max3_f32 v3, v44, v45, v3
v_max3_f32 v2, v46, v47, v2
v_max_f32 v2, v2, v3
v_mov_b32 v3, v2
v_mfma_f32_32x32x16_bf16 v[192:207], v[184:187], v[84:87], v[192:207]
s_nop 0
v_permlane32_swap_b32 v2, v3
s_nop 1
v_max_f32 v2, v2, v3
v_mul_f32_e64 v2, s52, v2
v_pk_fma_f32 v[32:33], v[32:33], s[52:53], v[2:3] op_sel_hi:[1,1,0] neg_lo:[0,0,1] neg_hi:[0,0,1]
v_pk_fma_f32 v[34:35], v[34:35], s[52:53], v[2:3] op_sel_hi:[1,1,0] neg_lo:[0,0,1] neg_hi:[0,0,1]
s_waitcnt lgkmcnt(0)
v_mfma_f32_32x32x16_bf16 v[16:31], v[128:131], v[96:99], v[224:239]
v_pk_fma_f32 v[36:37], v[36:37], s[52:53], v[2:3] op_sel_hi:[1,1,0] neg_lo:[0,0,1] neg_hi:[0,0,1]
v_pk_fma_f32 v[38:39], v[38:39], s[52:53], v[2:3] op_sel_hi:[1,1,0] neg_lo:[0,0,1] neg_hi:[0,0,1]
v_pk_fma_f32 v[40:41], v[40:41], s[52:53], v[2:3] op_sel_hi:[1,1,0] neg_lo:[0,0,1] neg_hi:[0,0,1]
v_pk_fma_f32 v[42:43], v[42:43], s[52:53], v[2:3] op_sel_hi:[1,1,0] neg_lo:[0,0,1] neg_hi:[0,0,1]
v_pk_fma_f32 v[44:45], v[44:45], s[52:53], v[2:3] op_sel_hi:[1,1,0] neg_lo:[0,0,1] neg_hi:[0,0,1]
v_pk_fma_f32 v[46:47], v[46:47], s[52:53], v[2:3] op_sel_hi:[1,1,0] neg_lo:[0,0,1] neg_hi:[0,0,1]
v_exp_f32 v32, v32
v_exp_f32 v33, v33
v_exp_f32 v34, v34
v_mfma_f32_32x32x16_bf16 v[48:63], v[112:115], v[96:99], v[240:255]
v_exp_f32 v35, v35
v_exp_f32 v36, v36
v_exp_f32 v37, v37
v_exp_f32 v38, v38
v_exp_f32 v39, v39
v_exp_f32 v40, v40
v_exp_f32 v41, v41
v_exp_f32 v42, v42
v_exp_f32 v43, v43
v_exp_f32 v44, v44
v_exp_f32 v45, v45
v_exp_f32 v46, v46
v_rcp_f32 v92, v200
v_exp_f32 v47, v47
v_pk_mul_f32 v[192:193], v[192:193], v[92:93] op_sel_hi:[1,0]
v_pk_mul_f32 v[194:195], v[194:195], v[92:93] op_sel_hi:[1,0]
v_pk_mul_f32 v[196:197], v[196:197], v[92:93] op_sel_hi:[1,0]
v_pk_mul_f32 v[198:199], v[198:199], v[92:93] op_sel_hi:[1,0]
v_cvt_pk_bf16_f32 v4, v192, v193
v_cvt_pk_bf16_f32 v5, v194, v195
v_cvt_pk_bf16_f32 v6, v196, v197
v_cvt_pk_bf16_f32 v7, v198, v199
buffer_store_dwordx4 v[4:7], v208, s[40:43], s71 offen offset:0 sc1
v_cvt_pk_bf16_f32 v80, v32, v33
v_cvt_pk_bf16_f32 v81, v34, v35
v_cvt_pk_bf16_f32 v82, v36, v37
v_cvt_pk_bf16_f32 v83, v38, v39
v_cvt_pk_bf16_f32 v84, v40, v41
v_cvt_pk_bf16_f32 v85, v42, v43
v_cvt_pk_bf16_f32 v86, v44, v45
v_cvt_pk_bf16_f32 v87, v46, v47
v_cndmask_b32 v88, 0, v84, vcc
v_cndmask_b32 v89, 0, v85, vcc
v_cndmask_b32 v90, 0, v86, vcc
v_cndmask_b32 v91, 0, v87, vcc
v_xor_b32 v84, v88, v84
v_xor_b32 v85, v89, v85
v_xor_b32 v86, v90, v86
v_xor_b32 v87, v91, v87
v_mfma_f32_32x32x16_bf16 v[144:159], v[180:183], v[80:83], 0
s_or_b32 s56, s5, s60
s_cbranch_scc0 L_np2
v_max_f32 v24, v24, v56
v_max_f32 v25, v25, v57
v_max_f32 v26, v26, v58
v_max_f32 v27, v27, v59
v_max_f32 v28, v28, v60
v_max_f32 v29, v29, v61
v_max_f32 v30, v30, v62
v_max_f32 v31, v31, v63
L_np2:
v_max3_f32 v2, v16, v17, v18
v_max3_f32 v3, v19, v20, v21
v_mfma_f32_32x32x16_bf16 v[144:159], v[172:175], v[88:91], v[144:159]
v_max3_f32 v2, v22, v23, v2
v_max3_f32 v3, v24, v25, v3
v_max3_f32 v2, v26, v27, v2
v_max3_f32 v3, v28, v29, v3
v_max3_f32 v2, v30, v31, v2
v_max_f32 v2, v2, v3
v_mov_b32 v3, v2
v_mfma_f32_32x32x16_bf16 v[144:159], v[188:191], v[84:87], v[144:159]
s_nop 0
s_barrier
v_permlane32_swap_b32 v2, v3
s_nop 1
v_max_f32 v2, v2, v3
v_mul_f32 v2, s52, v2
v_pk_fma_f32 v[16:17], v[16:17], s[52:53], v[2:3] op_sel_hi:[1,1,0] neg_lo:[0,0,1] neg_hi:[0,0,1]
v_pk_fma_f32 v[18:19], v[18:19], s[52:53], v[2:3] op_sel_hi:[1,1,0] neg_lo:[0,0,1] neg_hi:[0,0,1]
v_mfma_f32_32x32x16_bf16 v[32:47], v[136:139], v[104:107], v[224:239]
v_pk_fma_f32 v[20:21], v[20:21], s[52:53], v[2:3] op_sel_hi:[1,1,0] neg_lo:[0,0,1] neg_hi:[0,0,1]
v_pk_fma_f32 v[22:23], v[22:23], s[52:53], v[2:3] op_sel_hi:[1,1,0] neg_lo:[0,0,1] neg_hi:[0,0,1]
v_pk_fma_f32 v[24:25], v[24:25], s[52:53], v[2:3] op_sel_hi:[1,1,0] neg_lo:[0,0,1] neg_hi:[0,0,1]
v_pk_fma_f32 v[26:27], v[26:27], s[52:53], v[2:3] op_sel_hi:[1,1,0] neg_lo:[0,0,1] neg_hi:[0,0,1]
v_pk_fma_f32 v[28:29], v[28:29], s[52:53], v[2:3] op_sel_hi:[1,1,0] neg_lo:[0,0,1] neg_hi:[0,0,1]
v_pk_fma_f32 v[30:31], v[30:31], s[52:53], v[2:3] op_sel_hi:[1,1,0] neg_lo:[0,0,1] neg_hi:[0,0,1]
v_exp_f32 v16, v16
v_exp_f32 v17, v17
v_exp_f32_e64 v18, v18
v_mfma_f32_32x32x16_bf16 v[64:79], v[116:119], v[104:107], v[240:255]
v_exp_f32 v19, v19
v_exp_f32 v20, v20
v_exp_f32 v21, v21
v_exp_f32 v22, v22
v_exp_f32 v23, v23
v_exp_f32 v24, v24
v_exp_f32 v25, v25
v_exp_f32 v26, v26
v_exp_f32 v27, v27
v_exp_f32 v28, v28
v_exp_f32 v29, v29
v_exp_f32 v30, v30
v_rcp_f32 v92, v152
v_exp_f32 v31, v31
v_pk_mul_f32 v[144:145], v[144:145], v[92:93] op_sel_hi:[1,0]
v_pk_mul_f32 v[146:147], v[146:147], v[92:93] op_sel_hi:[1,0]
v_pk_mul_f32 v[148:149], v[148:149], v[92:93] op_sel_hi:[1,0]
v_pk_mul_f32 v[150:151], v[150:151], v[92:93] op_sel_hi:[1,0]
v_cvt_pk_bf16_f32 v8, v144, v145
v_cvt_pk_bf16_f32 v9, v146, v147
v_cvt_pk_bf16_f32 v10, v148, v149
v_cvt_pk_bf16_f32 v11, v150, v151
buffer_store_dwordx4 v[8:11], v208, s[40:43], s71 offen offset:1024 sc1
v_cvt_pk_bf16_f32 v80, v16, v17
v_cvt_pk_bf16_f32 v81, v18, v19
v_cvt_pk_bf16_f32 v82, v20, v21
v_cvt_pk_bf16_f32 v83, v22, v23
v_cvt_pk_bf16_f32 v84, v24, v25
v_cvt_pk_bf16_f32 v85, v26, v27
v_cvt_pk_bf16_f32 v86, v28, v29
v_cvt_pk_bf16_f32 v87, v30, v31
v_cndmask_b32 v88, 0, v84, vcc
v_cndmask_b32 v89, 0, v85, vcc
v_cndmask_b32 v90, 0, v86, vcc
v_cndmask_b32 v91, 0, v87, vcc
v_xor_b32 v84, v88, v84
v_xor_b32 v85, v89, v85
v_xor_b32 v86, v90, v86
v_xor_b32 v87, v91, v87
v_mfma_f32_32x32x16_bf16 v[192:207], v[160:163], v[80:83], 0
s_or_b32 s56, s5, s60
s_cbranch_scc0 L_np3
v_max_f32 v40, v40, v72
v_max_f32 v41, v41, v73
v_max_f32 v42, v42, v74
v_max_f32 v43, v43, v75
v_max_f32 v44, v44, v76
v_max_f32 v45, v45, v77
v_max_f32 v46, v46, v78
v_max_f32 v47, v47, v79
L_np3:
v_max3_f32 v2, v32, v33, v34
v_max3_f32 v3, v35, v36, v37
v_mfma_f32_32x32x16_bf16 v[192:207], v[120:123], v[88:91], v[192:207]
v_max3_f32 v2, v38, v39, v2
v_max3_f32 v3, v40, v41, v3
v_max3_f32 v2, v42, v43, v2
v_max3_f32 v3, v44, v45, v3
v_max3_f32 v2, v46, v47, v2
v_max_f32 v2, v2, v3
v_mov_b32 v3, v2
v_mfma_f32_32x32x16_bf16 v[192:207], v[168:171], v[84:87], v[192:207]
s_nop 0
v_permlane32_swap_b32 v2, v3
s_nop 1
v_max_f32 v2, v2, v3
v_mul_f32_e64 v2, s52, v2
v_pk_fma_f32 v[32:33], v[32:33], s[52:53], v[2:3] op_sel_hi:[1,1,0] neg_lo:[0,0,1] neg_hi:[0,0,1]
v_pk_fma_f32 v[34:35], v[34:35], s[52:53], v[2:3] op_sel_hi:[1,1,0] neg_lo:[0,0,1] neg_hi:[0,0,1]
v_pk_fma_f32 v[36:37], v[36:37], s[52:53], v[2:3] op_sel_hi:[1,1,0] neg_lo:[0,0,1] neg_hi:[0,0,1]
v_pk_fma_f32 v[38:39], v[38:39], s[52:53], v[2:3] op_sel_hi:[1,1,0] neg_lo:[0,0,1] neg_hi:[0,0,1]
v_pk_fma_f32 v[40:41], v[40:41], s[52:53], v[2:3] op_sel_hi:[1,1,0] neg_lo:[0,0,1] neg_hi:[0,0,1]
v_pk_fma_f32 v[42:43], v[42:43], s[52:53], v[2:3] op_sel_hi:[1,1,0] neg_lo:[0,0,1] neg_hi:[0,0,1]
v_pk_fma_f32 v[44:45], v[44:45], s[52:53], v[2:3] op_sel_hi:[1,1,0] neg_lo:[0,0,1] neg_hi:[0,0,1]
v_pk_fma_f32 v[46:47], v[46:47], s[52:53], v[2:3] op_sel_hi:[1,1,0] neg_lo:[0,0,1] neg_hi:[0,0,1]
v_exp_f32 v32, v32
v_exp_f32 v33, v33
v_exp_f32 v34, v34
v_exp_f32 v35, v35
v_exp_f32 v36, v36
v_exp_f32 v37, v37
v_exp_f32 v38, v38
v_exp_f32 v39, v39
v_exp_f32 v40, v40
v_exp_f32 v41, v41
v_exp_f32 v42, v42
v_exp_f32 v43, v43
v_exp_f32 v44, v44
v_exp_f32 v45, v45
v_exp_f32 v46, v46
v_rcp_f32 v92, v200
v_exp_f32_e64 v47, v47
v_pk_mul_f32 v[192:193], v[192:193], v[92:93] op_sel_hi:[1,0]
v_pk_mul_f32 v[194:195], v[194:195], v[92:93] op_sel_hi:[1,0]
v_pk_mul_f32 v[196:197], v[196:197], v[92:93] op_sel_hi:[1,0]
v_pk_mul_f32 v[198:199], v[198:199], v[92:93] op_sel_hi:[1,0]
v_cvt_pk_bf16_f32 v12, v192, v193
v_cvt_pk_bf16_f32 v13, v194, v195
v_cvt_pk_bf16_f32 v14, v196, v197
v_cvt_pk_bf16_f32 v15, v198, v199
buffer_store_dwordx4 v[12:15], v208, s[40:43], s70 offen offset:0 sc1
v_cvt_pk_bf16_f32 v80, v32, v33
v_cvt_pk_bf16_f32 v81, v34, v35
v_cvt_pk_bf16_f32 v82, v36, v37
v_cvt_pk_bf16_f32 v83, v38, v39
v_cvt_pk_bf16_f32 v84, v40, v41
v_cvt_pk_bf16_f32 v85, v42, v43
v_cvt_pk_bf16_f32 v86, v44, v45
v_cvt_pk_bf16_f32 v87, v46, v47
v_cndmask_b32 v88, 0, v84, vcc
v_cndmask_b32 v89, 0, v85, vcc
v_cndmask_b32 v90, 0, v86, vcc
v_cndmask_b32 v91, 0, v87, vcc
v_xor_b32 v84, v88, v84
v_xor_b32 v85, v89, v85
v_xor_b32 v86, v90, v86
v_xor_b32 v87, v91, v87
v_mfma_f32_32x32x16_bf16 v[144:159], v[164:167], v[80:83], 0
v_mfma_f32_32x32x16_bf16 v[144:159], v[124:127], v[88:91], v[144:159]
v_mfma_f32_32x32x16_bf16 v[144:159], v[172:175], v[84:87], v[144:159]
s_nop 7
s_nop 3
v_rcp_f32 v92, v152
s_nop 0
v_pk_mul_f32 v[144:145], v[144:145], v[92:93] op_sel_hi:[1,0]
v_pk_mul_f32 v[146:147], v[146:147], v[92:93] op_sel_hi:[1,0]
v_pk_mul_f32 v[148:149], v[148:149], v[92:93] op_sel_hi:[1,0]
v_pk_mul_f32 v[150:151], v[150:151], v[92:93] op_sel_hi:[1,0]
v_cvt_pk_bf16_f32 v16, v144, v145
v_cvt_pk_bf16_f32 v17, v146, v147
v_cvt_pk_bf16_f32 v18, v148, v149
v_cvt_pk_bf16_f32 v19, v150, v151
buffer_store_dwordx4 v[16:19], v208, s[40:43], s70 offen offset:1024 sc1
s_lshl_b32 s63, s12, 16
s_lshr_b32 s58, s14, 1
s_lshl_b32 s58, s58, 15
s_add_u32 s63, s63, s58
s_and_b32 s58, s14, 1
s_lshl_b32 s58, s58, 12
s_add_u32 s63, s63, s58
s_add_u32 s63, s63, 6291456
s_lshl_b32 m0, s14, 12
s_branch L_tail
L_compA2:
s_mov_b32 s74, 4194304
L_poa:
L_poa_f:
s_load_dwordx8 s[16:23], s[40:41], s15 offset:0 glc
L_poa_w:
s_sub_u32 s74, s74, 1
s_waitcnt lgkmcnt(0)
s_cbranch_scc1 L_poa_d
L_poa_c:
s_cmp_eq_u64 s[16:17], s[10:11]
s_cbranch_scc0 L_poa
s_cmp_eq_u64 s[18:19], s[10:11]
s_cbranch_scc0 L_poa
s_cmp_eq_u64 s[20:21], s[10:11]
s_cbranch_scc0 L_poa
s_cmp_eq_u64 s[22:23], s[10:11]
s_cbranch_scc0 L_poa
L_poa_d:
buffer_load_dwordx4 v208, s[40:43], s63 offen offset:0 sc1 lds
buffer_load_dwordx4 v208, s[40:43], s63 offen offset:1024 sc1 lds
buffer_load_dwordx4 v208, s[40:43], s63 offen offset:2048 sc1 lds
buffer_load_dwordx4 v208, s[40:43], s63 offen offset:3072 sc1 lds
s_add_u32 m0, m0, 16384
s_add_u32 s63, s63, 8192
buffer_load_dwordx4 v208, s[40:43], s63 offen offset:0 sc1 lds
buffer_load_dwordx4 v208, s[40:43], s63 offen offset:1024 sc1 lds
buffer_load_dwordx4 v208, s[40:43], s63 offen offset:2048 sc1 lds
buffer_load_dwordx4 v208, s[40:43], s63 offen offset:3072 sc1 lds
s_add_u32 m0, m0, 16384
s_add_u32 s63, s63, 8192
buffer_load_dwordx4 v208, s[40:43], s63 offen offset:0 sc1 lds
buffer_load_dwordx4 v208, s[40:43], s63 offen offset:1024 sc1 lds
buffer_load_dwordx4 v208, s[40:43], s63 offen offset:2048 sc1 lds
buffer_load_dwordx4 v208, s[40:43], s63 offen offset:3072 sc1 lds
s_add_u32 m0, m0, 16384
s_add_u32 s63, s63, 8192
buffer_load_dwordx4 v208, s[40:43], s63 offen offset:0 sc1 lds
buffer_load_dwordx4 v208, s[40:43], s63 offen offset:1024 sc1 lds
buffer_load_dwordx4 v208, s[40:43], s63 offen offset:2048 sc1 lds
buffer_load_dwordx4 v208, s[40:43], s63 offen offset:3072 sc1 lds
s_waitcnt vmcnt(12)
s_barrier
s_waitcnt vmcnt(4)
s_load_dwordx8 s[24:31], s[40:41], s7 glc
s_mov_b32 s74, 4194304
s_waitcnt vmcnt(0)
s_barrier
s_branch L_pob_w
.p2align 12
L_projA:
s_waitcnt vmcnt(0)
s_barrier
v_mov_b32 v2, s10
v_mov_b32_e64 v3, s11
s_lshl_b32 s56, s14, 2
s_lshl_b64 exec, 15, s56
s_barrier
buffer_store_dwordx2 v[2:3], v214, s[40:43], s30 offen sc1
s_mov_b64 exec, -1
s_barrier
s_setprio 1
v_mov_b32 v60, 98304
v_mov_b32 v61, 0
ds_write_b32 v60, v61
s_waitcnt lgkmcnt(0)
s_barrier
ds_read_b128 v[4:7], v208 offset:0
ds_read_b128 v[8:11], v208 offset:8192
ds_read_b128 v[12:15], v208 offset:1024
ds_read_b128 v[16:19], v208 offset:9216
s_waitcnt lgkmcnt(0)
v_mfma_f32_32x32x16_bf16 v[224:239], v[64:67], v[4:7], 0
ds_read_b128 v[20:23], v208 offset:2048
ds_read_b128 v[24:27], v208 offset:10240
v_mfma_f32_32x32x16_bf16 v[240:255], v[64:67], v[8:11], 0
ds_read_b128 v[28:31], v208 offset:3072
ds_read_b128 v[32:35], v208 offset:11264
v_mfma_f32_32x32x16_bf16 v[224:239], v[68:71], v[12:15], v[224:239]
v_mfma_f32_32x32x16_bf16 v[240:255], v[68:71], v[16:19], v[240:255]
s_waitcnt lgkmcnt(0)
v_mfma_f32_32x32x16_bf16 v[224:239], v[72:75], v[20:23], v[224:239]
ds_read_b128 v[36:39], v208 offset:4096
ds_read_b128 v[40:43], v208 offset:12288
v_mfma_f32_32x32x16_bf16 v[240:255], v[72:75], v[24:27], v[240:255]
ds_read_b128 v[44:47], v208 offset:5120
ds_read_b128 v[48:51], v208 offset:13312
v_mfma_f32_32x32x16_bf16 v[224:239], v[76:79], v[28:31], v[224:239]
v_mfma_f32_32x32x16_bf16 v[240:255], v[76:79], v[32:35], v[240:255]
s_waitcnt lgkmcnt(0)
v_mfma_f32_32x32x16_bf16 v[224:239], v[80:83], v[36:39], v[224:239]
ds_read_b128 v[4:7], v208 offset:6144
ds_read_b128 v[8:11], v208 offset:14336
v_mfma_f32_32x32x16_bf16 v[240:255], v[80:83], v[40:43], v[240:255]
ds_read_b128 v[12:15], v208 offset:7168
ds_read_b128 v[16:19], v208 offset:15360
v_mfma_f32_32x32x16_bf16 v[224:239], v[84:87], v[44:47], v[224:239]
v_mfma_f32_32x32x16_bf16 v[240:255], v[84:87], v[48:51], v[240:255]
s_waitcnt lgkmcnt(0)
v_mfma_f32_32x32x16_bf16 v[224:239], v[88:91], v[4:7], v[224:239]
s_barrier
ds_read_b128 v[20:23], v208 offset:16384
ds_read_b128 v[24:27], v208 offset:24576
v_mfma_f32_32x32x16_bf16 v[240:255], v[88:91], v[8:11], v[240:255]
ds_read_b128 v[28:31], v208 offset:17408
ds_read_b128 v[32:35], v208 offset:25600
v_mfma_f32_32x32x16_bf16 v[224:239], v[92:95], v[12:15], v[224:239]
v_mfma_f32_32x32x16_bf16 v[240:255], v[92:95], v[16:19], v[240:255]
s_waitcnt lgkmcnt(0)
v_mfma_f32_32x32x16_bf16 v[224:239], v[96:99], v[20:23], v[224:239]
ds_read_b128 v[36:39], v208 offset:18432
ds_read_b128 v[40:43], v208 offset:26624
v_mfma_f32_32x32x16_bf16 v[240:255], v[96:99], v[24:27], v[240:255]
ds_read_b128 v[44:47], v208 offset:19456
ds_read_b128 v[48:51], v208 offset:27648
v_mfma_f32_32x32x16_bf16 v[224:239], v[100:103], v[28:31], v[224:239]
v_mfma_f32_32x32x16_bf16 v[240:255], v[100:103], v[32:35], v[240:255]
s_waitcnt lgkmcnt(0)
v_mfma_f32_32x32x16_bf16 v[224:239], v[104:107], v[36:39], v[224:239]
ds_read_b128 v[4:7], v208 offset:20480
ds_read_b128 v[8:11], v208 offset:28672
v_mfma_f32_32x32x16_bf16 v[240:255], v[104:107], v[40:43], v[240:255]
ds_read_b128 v[12:15], v208 offset:21504
ds_read_b128 v[16:19], v208 offset:29696
v_mfma_f32_32x32x16_bf16 v[224:239], v[108:111], v[44:47], v[224:239]
v_mfma_f32_32x32x16_bf16 v[240:255], v[108:111], v[48:51], v[240:255]
s_waitcnt lgkmcnt(0)
v_mfma_f32_32x32x16_bf16 v[224:239], v[112:115], v[4:7], v[224:239]
ds_read_b128 v[20:23], v208 offset:22528
ds_read_b128 v[24:27], v208 offset:30720
v_mfma_f32_32x32x16_bf16 v[240:255], v[112:115], v[8:11], v[240:255]
ds_read_b128 v[28:31], v208 offset:23552
ds_read_b128 v[32:35], v208 offset:31744
v_mfma_f32_32x32x16_bf16 v[224:239], v[116:119], v[12:15], v[224:239]
v_mfma_f32_32x32x16_bf16 v[240:255], v[116:119], v[16:19], v[240:255]
s_waitcnt lgkmcnt(0)
v_mfma_f32_32x32x16_bf16 v[224:239], v[120:123], v[20:23], v[224:239]
ds_read_b128 v[36:39], v208 offset:32768
ds_read_b128 v[40:43], v208 offset:40960
v_mfma_f32_32x32x16_bf16 v[240:255], v[120:123], v[24:27], v[240:255]
ds_read_b128 v[44:47], v208 offset:33792
ds_read_b128 v[48:51], v208 offset:41984
v_mfma_f32_32x32x16_bf16 v[224:239], v[124:127], v[28:31], v[224:239]
v_mfma_f32_32x32x16_bf16 v[240:255], v[124:127], v[32:35], v[240:255]
s_waitcnt lgkmcnt(0)
v_mfma_f32_32x32x16_bf16 v[224:239], v[128:131], v[36:39], v[224:239]
ds_read_b128 v[4:7], v208 offset:34816
ds_read_b128 v[8:11], v208 offset:43008
v_mfma_f32_32x32x16_bf16 v[240:255], v[128:131], v[40:43], v[240:255]
ds_read_b128 v[12:15], v208 offset:35840
ds_read_b128 v[16:19], v208 offset:44032
v_mfma_f32_32x32x16_bf16 v[224:239], v[132:135], v[44:47], v[224:239]
v_mfma_f32_32x32x16_bf16 v[240:255], v[132:135], v[48:51], v[240:255]
s_waitcnt lgkmcnt(0)
v_mfma_f32_32x32x16_bf16 v[224:239], v[136:139], v[4:7], v[224:239]
ds_read_b128 v[20:23], v208 offset:36864
ds_read_b128 v[24:27], v208 offset:45056
v_mfma_f32_32x32x16_bf16 v[240:255], v[136:139], v[8:11], v[240:255]
ds_read_b128 v[28:31], v208 offset:37888
ds_read_b128 v[32:35], v208 offset:46080
v_mfma_f32_32x32x16_bf16 v[224:239], v[140:143], v[12:15], v[224:239]
v_mfma_f32_32x32x16_bf16 v[240:255], v[140:143], v[16:19], v[240:255]
s_waitcnt lgkmcnt(0)
v_mfma_f32_32x32x16_bf16 v[224:239], v[144:147], v[20:23], v[224:239]
ds_read_b128 v[36:39], v208 offset:38912
ds_read_b128 v[40:43], v208 offset:47104
v_mfma_f32_32x32x16_bf16 v[240:255], v[144:147], v[24:27], v[240:255]
ds_read_b128 v[44:47], v208 offset:39936
ds_read_b128 v[48:51], v208 offset:48128
v_mfma_f32_32x32x16_bf16 v[224:239], v[148:151], v[28:31], v[224:239]
v_mfma_f32_32x32x16_bf16 v[240:255], v[148:151], v[32:35], v[240:255]
s_waitcnt lgkmcnt(0)
v_mfma_f32_32x32x16_bf16 v[224:239], v[152:155], v[36:39], v[224:239]
ds_read_b128 v[4:7], v208 offset:49152
ds_read_b128 v[8:11], v208 offset:57344
v_mfma_f32_32x32x16_bf16 v[240:255], v[152:155], v[40:43], v[240:255]
ds_read_b128 v[12:15], v208 offset:50176
ds_read_b128 v[16:19], v208 offset:58368
v_mfma_f32_32x32x16_bf16 v[224:239], v[156:159], v[44:47], v[224:239]
v_mfma_f32_32x32x16_bf16 v[240:255], v[156:159], v[48:51], v[240:255]
s_waitcnt lgkmcnt(0)
v_mfma_f32_32x32x16_bf16 v[224:239], v[160:163], v[4:7], v[224:239]
ds_read_b128 v[20:23], v208 offset:51200
ds_read_b128 v[24:27], v208 offset:59392
v_mfma_f32_32x32x16_bf16 v[240:255], v[160:163], v[8:11], v[240:255]
ds_read_b128 v[28:31], v208 offset:52224
ds_read_b128 v[32:35], v208 offset:60416
v_mfma_f32_32x32x16_bf16 v[224:239], v[164:167], v[12:15], v[224:239]
v_mfma_f32_32x32x16_bf16 v[240:255], v[164:167], v[16:19], v[240:255]
s_waitcnt lgkmcnt(0)
v_mfma_f32_32x32x16_bf16 v[224:239], v[168:171], v[20:23], v[224:239]
ds_read_b128 v[36:39], v208 offset:53248
ds_read_b128 v[40:43], v208 offset:61440
v_mfma_f32_32x32x16_bf16 v[240:255], v[168:171], v[24:27], v[240:255]
ds_read_b128 v[44:47], v208 offset:54272
ds_read_b128 v[48:51], v208 offset:62464
v_mfma_f32_32x32x16_bf16 v[224:239], v[172:175], v[28:31], v[224:239]
v_mfma_f32_32x32x16_bf16 v[240:255], v[172:175], v[32:35], v[240:255]
s_waitcnt lgkmcnt(0)
v_mfma_f32_32x32x16_bf16 v[224:239], v[176:179], v[36:39], v[224:239]
ds_read_b128 v[4:7], v208 offset:55296
ds_read_b128 v[8:11], v208 offset:63488
v_mfma_f32_32x32x16_bf16 v[240:255], v[176:179], v[40:43], v[240:255]
ds_read_b128 v[12:15], v208 offset:56320
ds_read_b128 v[16:19], v208 offset:64512
v_mfma_f32_32x32x16_bf16 v[224:239], v[180:183], v[44:47], v[224:239]
v_mfma_f32_32x32x16_bf16 v[240:255], v[180:183], v[48:51], v[240:255]
s_waitcnt lgkmcnt(0)
v_mfma_f32_32x32x16_bf16 v[224:239], v[184:187], v[4:7], v[224:239]
v_mfma_f32_32x32x16_bf16 v[240:255], v[184:187], v[8:11], v[240:255]
v_mfma_f32_32x32x16_bf16 v[224:239], v[188:191], v[12:15], v[224:239]
v_mfma_f32_32x32x16_bf16 v[240:255], v[188:191], v[16:19], v[240:255]
s_nop 7
s_nop 2
s_nop 0
v_cvt_pk_bf16_f32 v4, v224, v225
v_cvt_pk_bf16_f32 v5, v226, v227
v_cvt_pk_bf16_f32 v6, v228, v229
v_cvt_pk_bf16_f32 v7, v230, v231
v_cvt_pk_bf16_f32 v8, v232, v233
v_cvt_pk_bf16_f32 v9, v234, v235
v_cvt_pk_bf16_f32 v10, v236, v237
v_cvt_pk_bf16_f32 v11, v238, v239
s_add_u32 s23, s22, 32768
s_nop 0
v_permlane32_swap_b32 v4, v6
v_permlane32_swap_b32 v5, v7
v_permlane32_swap_b32 v8, v10
v_permlane32_swap_b32_e64 v9, v11
ds_write_b128 v216, v[4:7] offset:0
ds_write_b128 v217, v[8:11] offset:0
v_cvt_pk_bf16_f32 v12, v240, v241
v_cvt_pk_bf16_f32 v13, v242, v243
v_cvt_pk_bf16_f32 v14, v244, v245
v_cvt_pk_bf16_f32 v15, v246, v247
v_cvt_pk_bf16_f32 v16, v248, v249
v_cvt_pk_bf16_f32 v17, v250, v251
v_cvt_pk_bf16_f32 v18, v252, v253
v_cvt_pk_bf16_f32 v19, v254, v255
s_add_u32 s25, s24, 32768
s_nop 0
v_permlane32_swap_b32 v12, v14
v_permlane32_swap_b32 v13, v15
v_permlane32_swap_b32 v16, v18
v_permlane32_swap_b32_e64 v17, v19
ds_write_b128 v216, v[12:15] offset:2048
ds_write_b128 v217, v[16:19] offset:2048
s_waitcnt lgkmcnt(0)
s_nop 0
ds_read_b128 v[20:23], v218 offset:0
ds_read_b128 v[24:27], v218 offset:1024
ds_read_b128 v[28:31], v218 offset:2048
ds_read_b128 v[32:35], v218 offset:3072
s_mov_b32 s74, 4194304
L_qs:
ds_read_b32 v61, v60
s_waitcnt lgkmcnt(0)
v_readfirstlane_b32 s56, v61
s_sub_u32 s74, s74, 1
s_cbranch_scc1 L_qs_d
s_bitcmp1_b32 s56, 6
s_cbranch_scc1 L_qs_d
s_sleep 1
s_branch L_qs
L_qs_d:
s_waitcnt lgkmcnt(3)
buffer_store_dwordx4 v[20:23], v212, s[44:47], s22 offen sc1
s_waitcnt lgkmcnt(2)
buffer_store_dwordx4 v[24:27], v212, s[44:47], s23 offen sc1
s_waitcnt lgkmcnt(1)
buffer_store_dwordx4 v[28:31], v212, s[44:47], s24 offen sc1
s_waitcnt lgkmcnt(0)
buffer_store_dwordx4 v[32:35], v212, s[44:47], s25 offen sc1
s_barrier
s_barrier
s_branch L_fin
L_gB:
s_mul_i32 s58, s14, 12288
v_add_u32 v216, s58, v208
s_add_u32 s56, s58, 49152
v_add_u32_e64 v217, s56, v209
s_mov_b32 s55, 2
s_lshl_b32 s56, s5, 2
s_add_u32 s56, s56, 2
s_lshl_b32 s57, s56, 3
s_add_u32 s57, s57, s6
s_lshl_b32 s57, s57, 2
s_add_u32 s57, s57, s14
s_lshl_b32 s57, s57, 10
s_add_u32 s70, s57, 8388608
s_add_u32 s71, s70, 32768
s_mov_b32 s62, 0
s_mov_b32 s63, 0
v_add_u32 v8, s62, v4
v_add_u32 v10, s62, v6
v_add_u32 v11, s62, v7
v_add_u32_e64 v9, s62, v5
s_waitcnt lgkmcnt(0)
s_mul_i32 s10, s10, 0x9e3779b1
s_add_u32 s10, s10, 0x7f4a7c15
s_mul_i32 s11, s11, 0x2c9277b5
s_add_u32 s11, s11, 0xac564b05
s_xor_b32 s11, s11, s10
s_barrier
ds_read_b128 v[40:43], v8 offset:8192
ds_read_b64_tr_b16 v[16:17], v10 offset:8192
ds_read_b64_tr_b16 v[18:19], v10 offset:8704
ds_read_b128 v[44:47], v8 offset:10240
ds_read_b128 v[48:51], v8 offset:0
ds_read_b128 v[52:55], v8 offset:2048
ds_read_b64_tr_b16 v[20:21], v11 offset:8192
ds_read_b64_tr_b16 v[22:23], v11 offset:8704
s_waitcnt lgkmcnt(5)
v_mfma_f32_16x16x32_bf16 v[128:131], v[16:19], v[40:43], v[128:131]
ds_read_b64_tr_b16 v[24:25], v10 offset:16384
ds_read_b64_tr_b16 v[26:27], v10 offset:16896
s_waitcnt lgkmcnt(6)
v_mfma_f32_16x16x32_bf16 v[132:135], v[16:19], v[44:47], v[132:135]
ds_read_b64_tr_b16 v[28:29], v11 offset:16384
ds_read_b64_tr_b16 v[30:31], v11 offset:16896
s_waitcnt lgkmcnt(7)
v_mfma_f32_16x16x32_bf16 v[136:139], v[16:19], v[48:51], v[136:139]
ds_read_b64_tr_b16 v[32:33], v10 offset:0
ds_read_b64_tr_b16 v[34:35], v10 offset:512
s_waitcnt lgkmcnt(8)
v_mfma_f32_16x16x32_bf16 v[140:143], v[16:19], v[52:55], v[140:143]
ds_read_b64_tr_b16 v[36:37], v11 offset:0
ds_read_b64_tr_b16 v[38:39], v11 offset:512
s_waitcnt lgkmcnt(8)
v_mfma_f32_16x16x32_bf16 v[144:147], v[20:23], v[40:43], v[144:147]
ds_read_b128 v[224:227], v85 offset:2048
ds_read_b128 v[228:231], v85 offset:3072
v_mfma_f32_16x16x32_bf16 v[148:151], v[20:23], v[44:47], v[148:151]
ds_read_b128 v[232:235], v85 offset:4096
ds_read_b128 v[236:239], v85 offset:5120
v_mfma_f32_16x16x32_bf16 v[152:155], v[20:23], v[48:51], v[152:155]
ds_read_b128 v[240:243], v85 offset:6144
ds_read_b128 v[244:247], v85 offset:7168
v_mfma_f32_16x16x32_bf16 v[156:159], v[20:23], v[52:55], v[156:159]
ds_read_b128 v[248:251], v85 offset:8192
ds_read_b128 v[252:255], v85 offset:9216
s_waitcnt lgkmcnt(8)
L_g_b:
v_mfma_f32_16x16x32_bf16 v[160:163], v[40:43], v[24:27], v[160:163]
ds_read_b128 v[60:63], v9 offset:8192
v_mfma_f32_16x16x32_bf16 v[168:171], v[44:47], v[24:27], v[168:171]
ds_read_b64_tr_b16 v[16:17], v10 offset:12288
v_mfma_f32_16x16x32_bf16 v[176:179], v[48:51], v[24:27], v[176:179]
ds_read_b64_tr_b16 v[18:19], v10 offset:12800
v_mfma_f32_16x16x32_bf16 v[184:187], v[52:55], v[24:27], v[184:187]
ds_read_b128 v[64:67], v9 offset:10240
v_mfma_f32_16x16x32_bf16 v[164:167], v[40:43], v[28:31], v[164:167]
ds_read_b128 v[68:71], v9 offset:0
v_mfma_f32_16x16x32_bf16 v[172:175], v[44:47], v[28:31], v[172:175]
ds_read_b128 v[72:75], v9 offset:2048
v_mfma_f32_16x16x32_bf16 v[180:183], v[48:51], v[28:31], v[180:183]
ds_read_b64_tr_b16 v[20:21], v11 offset:12288
v_mfma_f32_16x16x32_bf16 v[188:191], v[52:55], v[28:31], v[188:191]
ds_read_b64_tr_b16 v[22:23], v11 offset:12800
v_mfma_f32_16x16x32_bf16 v[96:99], v[32:35], v[40:43], v[96:99]
ds_read_b64_tr_b16 v[24:25], v10 offset:20480
v_mfma_f32_16x16x32_bf16 v[100:103], v[32:35], v[44:47], v[100:103]
ds_read_b64_tr_b16 v[26:27], v10 offset:20992
v_mfma_f32_16x16x32_bf16 v[104:107], v[32:35], v[48:51], v[104:107]
ds_read_b64_tr_b16 v[28:29], v11 offset:20480
v_mfma_f32_16x16x32_bf16 v[108:111], v[32:35], v[52:55], v[108:111]
ds_read_b64_tr_b16 v[30:31], v11 offset:20992
v_mfma_f32_16x16x32_bf16 v[112:115], v[36:39], v[40:43], v[112:115]
ds_read_b64_tr_b16 v[32:33], v10 offset:4096
v_mfma_f32_16x16x32_bf16 v[116:119], v[36:39], v[44:47], v[116:119]
ds_read_b64_tr_b16 v[34:35], v10 offset:4608
v_mfma_f32_16x16x32_bf16 v[120:123], v[36:39], v[48:51], v[120:123]
v_mfma_f32_16x16x32_bf16 v[124:127], v[36:39], v[52:55], v[124:127]
s_waitcnt lgkmcnt(6)
v_mfma_f32_16x16x32_bf16 v[128:131], v[16:19], v[60:63], v[128:131]
ds_read_b64_tr_b16 v[36:37], v11 offset:4096
v_mfma_f32_16x16x32_bf16 v[132:135], v[16:19], v[64:67], v[132:135]
ds_read_b64_tr_b16 v[38:39], v11 offset:4608
v_mfma_f32_16x16x32_bf16 v[136:139], v[16:19], v[68:71], v[136:139]
s_add_u32 s62, s62, 43008
s_cmp_ge_u32 s62, 129024
v_mfma_f32_16x16x32_bf16 v[140:143], v[16:19], v[72:75], v[140:143]
s_cselect_b32 s62, 0, s62
s_add_u32 s63, s63, 1
v_mfma_f32_16x16x32_bf16 v[144:147], v[20:23], v[60:63], v[144:147]
v_add_u32_e64 v8, s62, v4
s_cmp_eq_u32 s63, 8
v_mfma_f32_16x16x32_bf16 v[148:151], v[20:23], v[64:67], v[148:151]
v_add_u32_e64 v10, s62, v6
v_mfma_f32_16x16x32_bf16 v[152:155], v[20:23], v[68:71], v[152:155]
v_add_u32 v11, s62, v7
v_add_u32 v9, s62, v5
v_mfma_f32_16x16x32_bf16 v[156:159], v[20:23], v[72:75], v[156:159]
s_waitcnt lgkmcnt(0)
s_barrier
v_mfma_f32_16x16x32_bf16 v[160:163], v[60:63], v[24:27], v[160:163]
s_cbranch_scc1 L_gx_b
ds_read_b128 v[40:43], v8 offset:8192
v_mfma_f32_16x16x32_bf16 v[168:171], v[64:67], v[24:27], v[168:171]
ds_read_b64_tr_b16 v[16:17], v10 offset:8192
v_mfma_f32_16x16x32_bf16 v[176:179], v[68:71], v[24:27], v[176:179]
ds_read_b64_tr_b16 v[18:19], v10 offset:8704
v_mfma_f32_16x16x32_bf16 v[184:187], v[72:75], v[24:27], v[184:187]
ds_read_b128 v[44:47], v8 offset:10240
v_mfma_f32_16x16x32_bf16 v[164:167], v[60:63], v[28:31], v[164:167]
ds_read_b128 v[48:51], v8 offset:0
v_mfma_f32_16x16x32_bf16 v[172:175], v[64:67], v[28:31], v[172:175]
ds_read_b128 v[52:55], v8 offset:2048
v_mfma_f32_16x16x32_bf16 v[180:183], v[68:71], v[28:31], v[180:183]
ds_read_b64_tr_b16 v[20:21], v11 offset:8192
v_mfma_f32_16x16x32_bf16 v[188:191], v[72:75], v[28:31], v[188:191]
ds_read_b64_tr_b16 v[22:23], v11 offset:8704
v_mfma_f32_16x16x32_bf16 v[96:99], v[32:35], v[60:63], v[96:99]
ds_read_b64_tr_b16 v[24:25], v10 offset:16384
v_mfma_f32_16x16x32_bf16 v[100:103], v[32:35], v[64:67], v[100:103]
ds_read_b64_tr_b16 v[26:27], v10 offset:16896
v_mfma_f32_16x16x32_bf16 v[104:107], v[32:35], v[68:71], v[104:107]
ds_read_b64_tr_b16 v[28:29], v11 offset:16384
v_mfma_f32_16x16x32_bf16 v[108:111], v[32:35], v[72:75], v[108:111]
ds_read_b64_tr_b16 v[30:31], v11 offset:16896
v_mfma_f32_16x16x32_bf16 v[112:115], v[36:39], v[60:63], v[112:115]
ds_read_b64_tr_b16 v[32:33], v10 offset:0
v_mfma_f32_16x16x32_bf16 v[116:119], v[36:39], v[64:67], v[116:119]
ds_read_b64_tr_b16 v[34:35], v10 offset:512
v_mfma_f32_16x16x32_bf16 v[120:123], v[36:39], v[68:71], v[120:123]
v_mfma_f32_16x16x32_bf16 v[124:127], v[36:39], v[72:75], v[124:127]
s_waitcnt lgkmcnt(6)
v_mfma_f32_16x16x32_bf16 v[128:131], v[16:19], v[40:43], v[128:131]
ds_read_b64_tr_b16 v[36:37], v11 offset:0
v_mfma_f32_16x16x32_bf16 v[132:135], v[16:19], v[44:47], v[132:135]
ds_read_b64_tr_b16 v[38:39], v11 offset:512
v_mfma_f32_16x16x32_bf16 v[136:139], v[16:19], v[48:51], v[136:139]
v_mfma_f32_16x16x32_bf16 v[140:143], v[16:19], v[52:55], v[140:143]
v_mfma_f32_16x16x32_bf16 v[144:147], v[20:23], v[40:43], v[144:147]
v_mfma_f32_16x16x32_bf16 v[148:151], v[20:23], v[44:47], v[148:151]
v_mfma_f32_16x16x32_bf16 v[152:155], v[20:23], v[48:51], v[152:155]
v_mfma_f32_16x16x32_bf16 v[156:159], v[20:23], v[52:55], v[156:159]
s_waitcnt lgkmcnt(0)
s_branch L_g_b
L_gx_b:
v_mfma_f32_16x16x32_bf16 v[168:171], v[64:67], v[24:27], v[168:171]
v_mfma_f32_16x16x32_bf16 v[176:179], v[68:71], v[24:27], v[176:179]
v_mfma_f32_16x16x32_bf16 v[184:187], v[72:75], v[24:27], v[184:187]
v_mfma_f32_16x16x32_bf16 v[164:167], v[60:63], v[28:31], v[164:167]
v_mfma_f32_16x16x32_bf16 v[172:175], v[64:67], v[28:31], v[172:175]
v_mfma_f32_16x16x32_bf16 v[180:183], v[68:71], v[28:31], v[180:183]
v_mfma_f32_16x16x32_bf16 v[188:191], v[72:75], v[28:31], v[188:191]
v_mfma_f32_16x16x32_bf16 v[96:99], v[32:35], v[60:63], v[96:99]
v_mfma_f32_16x16x32_bf16 v[100:103], v[32:35], v[64:67], v[100:103]
v_mfma_f32_16x16x32_bf16 v[104:107], v[32:35], v[68:71], v[104:107]
v_mfma_f32_16x16x32_bf16 v[108:111], v[32:35], v[72:75], v[108:111]
v_mfma_f32_16x16x32_bf16 v[112:115], v[36:39], v[60:63], v[112:115]
v_mfma_f32_16x16x32_bf16 v[116:119], v[36:39], v[64:67], v[116:119]
v_mfma_f32_16x16x32_bf16 v[120:123], v[36:39], v[68:71], v[120:123]
v_mfma_f32_16x16x32_bf16 v[124:127], v[36:39], v[72:75], v[124:127]
v_cvt_pk_bf16_f32 v128, v128, v129
v_cvt_pk_bf16_f32 v129, v130, v131
v_cvt_pk_bf16_f32 v130, v132, v133
v_cvt_pk_bf16_f32 v131, v134, v135
v_cvt_pk_bf16_f32 v144, v144, v145
v_cvt_pk_bf16_f32 v145, v146, v147
v_cvt_pk_bf16_f32 v146, v148, v149
v_cvt_pk_bf16_f32 v147, v150, v151
v_permlane16_swap_b32 v128, v130
v_permlane16_swap_b32 v129, v131
buffer_store_dwordx4 v[128:131], v208, s[40:43], s64 offen offset:2048 sc1
v_cvt_pk_bf16_f32 v160, v160, v161
v_cvt_pk_bf16_f32 v161, v162, v163
v_cvt_pk_bf16_f32 v162, v164, v165
v_cvt_pk_bf16_f32 v163, v166, v167
v_permlane16_swap_b32 v144, v146
v_permlane16_swap_b32 v145, v147
buffer_store_dwordx4 v[144:147], v208, s[40:43], s65 offen offset:2048 sc1
ds_write_b128 v81, v[128:131] offset:2048
v_cvt_pk_bf16_f32 v168, v168, v169
v_cvt_pk_bf16_f32 v169, v170, v171
v_cvt_pk_bf16_f32 v170, v172, v173
v_cvt_pk_bf16_f32 v171, v174, v175
v_permlane32_swap_b32 v160, v162
v_permlane32_swap_b32 v161, v163
buffer_store_dwordx4 v[160:163], v213, s[40:43], s66 offen offset:2048 sc1
ds_write_b128 v81, v[144:147] offset:14336
v_cvt_pk_bf16_f32 v136, v136, v137
v_cvt_pk_bf16_f32 v137, v138, v139
v_cvt_pk_bf16_f32 v138, v140, v141
v_cvt_pk_bf16_f32 v139, v142, v143
v_permlane32_swap_b32 v168, v170
v_permlane32_swap_b32 v169, v171
buffer_store_dwordx4 v[168:171], v213, s[40:43], s66 offen offset:2560 sc1
ds_write_b128 v82, v[160:163] offset:2048
v_cvt_pk_bf16_f32 v152, v152, v153
v_cvt_pk_bf16_f32 v153, v154, v155
v_cvt_pk_bf16_f32 v154, v156, v157
v_cvt_pk_bf16_f32 v155, v158, v159
v_permlane16_swap_b32 v136, v138
v_permlane16_swap_b32 v137, v139
ds_write_b128 v82, v[168:171] offset:2560
v_cvt_pk_bf16_f32 v176, v176, v177
v_cvt_pk_bf16_f32 v177, v178, v179
v_cvt_pk_bf16_f32 v178, v180, v181
v_cvt_pk_bf16_f32 v179, v182, v183
v_permlane16_swap_b32 v152, v154
v_permlane16_swap_b32 v153, v155
ds_write_b128 v81, v[136:139] offset:0
v_cvt_pk_bf16_f32 v184, v184, v185
v_cvt_pk_bf16_f32 v185, v186, v187
v_cvt_pk_bf16_f32 v186, v188, v189
v_cvt_pk_bf16_f32 v187, v190, v191
v_permlane32_swap_b32 v176, v178
v_permlane32_swap_b32 v177, v179
ds_write_b128 v81, v[152:155] offset:12288
v_pk_mul_f32 v[96:97], v[96:97], s[52:53]
v_pk_mul_f32 v[98:99], v[98:99], s[52:53]
v_pk_mul_f32 v[100:101], v[100:101], s[52:53]
v_pk_mul_f32 v[102:103], v[102:103], s[52:53]
v_cvt_pk_bf16_f32 v96, v96, v97
v_cvt_pk_bf16_f32 v97, v98, v99
v_cvt_pk_bf16_f32 v98, v100, v101
v_cvt_pk_bf16_f32 v99, v102, v103
v_permlane32_swap_b32 v184, v186
v_permlane32_swap_b32 v185, v187
ds_write_b128 v82, v[176:179] offset:0
v_pk_mul_f32 v[104:105], v[104:105], s[52:53]
v_pk_mul_f32 v[106:107], v[106:107], s[52:53]
v_pk_mul_f32 v[108:109], v[108:109], s[52:53]
v_pk_mul_f32 v[110:111], v[110:111], s[52:53]
v_cvt_pk_bf16_f32 v104, v104, v105
v_cvt_pk_bf16_f32 v105, v106, v107
v_cvt_pk_bf16_f32 v106, v108, v109
v_cvt_pk_bf16_f32 v107, v110, v111
v_permlane16_swap_b32 v96, v98
v_permlane16_swap_b32 v97, v99
ds_write_b128 v82, v[184:187] offset:512
v_pk_mul_f32 v[112:113], v[112:113], s[52:53]
v_pk_mul_f32 v[114:115], v[114:115], s[52:53]
v_pk_mul_f32 v[116:117], v[116:117], s[52:53]
v_pk_mul_f32 v[118:119], v[118:119], s[52:53]
v_cvt_pk_bf16_f32 v112, v112, v113
v_cvt_pk_bf16_f32 v113, v114, v115
v_cvt_pk_bf16_f32 v114, v116, v117
v_cvt_pk_bf16_f32 v115, v118, v119
v_permlane16_swap_b32 v104, v106
v_permlane16_swap_b32 v105, v107
ds_write_b128 v83, v[96:99] offset:2048
v_pk_mul_f32 v[120:121], v[120:121], s[52:53]
v_pk_mul_f32 v[122:123], v[122:123], s[52:53]
v_pk_mul_f32 v[124:125], v[124:125], s[52:53]
v_pk_mul_f32 v[126:127], v[126:127], s[52:53]
v_cvt_pk_bf16_f32 v120, v120, v121
v_cvt_pk_bf16_f32 v121, v122, v123
v_cvt_pk_bf16_f32 v122, v124, v125
v_cvt_pk_bf16_f32 v123, v126, v127
v_permlane16_swap_b32 v112, v114
v_permlane16_swap_b32 v113, v115
ds_write_b128 v83, v[104:107] offset:0
s_nop 0
v_permlane16_swap_b32 v120, v122
v_permlane16_swap_b32_e64 v121, v123
ds_write_b128 v83, v[112:115] offset:14336
ds_write_b128 v83, v[120:123] offset:12288
s_setprio 2
s_waitcnt lgkmcnt(0)
s_barrier
ds_read_b128 v[4:7], v216 offset:2048
ds_read_b128 v[8:11], v216 offset:3072
ds_read_b128 v[16:19], v216 offset:11264
s_mov_b64 exec, s[72:73]
ds_read_b128 v[200:203], v217 offset:11264
ds_read_b128 v[204:207], v217 offset:11776
s_mov_b64 exec, -1
ds_read_b128 v[12:15], v216 offset:10240
s_mov_b64 exec, s[72:73]
ds_read_b128 v[192:195], v217 offset:10240
ds_read_b128 v[196:199], v217 offset:10752
s_mov_b64 exec, -1
s_add_u32 s56, s69, 32
s_waitcnt vmcnt(0)
v_mov_b32 v2, s10
v_mov_b32_e64 v3, s11
s_mov_b32 exec_hi, 0
s_mov_b32 exec_lo, 3
buffer_store_dwordx2 v[2:3], v214, s[40:43], s56 offen sc1
s_mov_b64 exec, -1
buffer_store_dwordx4 v[136:139], v208, s[40:43], s64 offen offset:0 sc1
buffer_store_dwordx4 v[152:155], v208, s[40:43], s65 offen offset:0 sc1
buffer_store_dwordx4 v[176:179], v213, s[40:43], s66 offen offset:0 sc1
buffer_store_dwordx4 v[184:187], v213, s[40:43], s66 offen offset:512 sc1
s_setprio 0
s_waitcnt lgkmcnt(5)
v_mfma_f32_32x32x16_bf16 v[64:79], v[16:19], v[8:11], v[224:239]
s_waitcnt lgkmcnt(0)
s_nop 7
s_nop 2
v_exp_f32 v64, v64
v_exp_f32 v65, v65
v_exp_f32 v66, v66
v_exp_f32 v67, v67
v_exp_f32 v68, v68
v_exp_f32 v69, v69
v_mfma_f32_32x32x16_bf16 v[80:95], v[12:15], v[4:7], v[224:239]
v_exp_f32 v70, v70
v_exp_f32 v71, v71
v_cvt_pk_bf16_f32 v48, v64, v65
v_cvt_pk_bf16_f32 v49, v66, v67
v_cvt_pk_bf16_f32 v50, v68, v69
v_cvt_pk_bf16_f32 v51, v70, v71
v_exp_f32 v72, v72
v_exp_f32 v73, v73
v_mfma_f32_32x32x16_bf16 v[112:127], v[200:203], v[48:51], 0
v_exp_f32 v74, v74
v_exp_f32 v75, v75
v_exp_f32 v76, v76
v_exp_f32 v77, v77
v_exp_f32 v78, v78
v_exp_f32 v79, v79
v_cvt_pk_bf16_f32 v52, v72, v73
v_cvt_pk_bf16_f32 v53, v74, v75
v_cvt_pk_bf16_f32 v54, v76, v77
v_cvt_pk_bf16_f32 v55, v78, v79
v_exp_f32 v80, v80
v_exp_f32 v81, v81
v_mfma_f32_32x32x16_bf16 v[112:127], v[204:207], v[52:55], v[112:127]
ds_read_b128 v[16:19], v216 offset:9216
s_mov_b64 exec, s[72:73]
ds_read_b128 v[200:203], v217 offset:9216
ds_read_b128 v[204:207], v217 offset:9728
s_mov_b64 exec, -1
v_exp_f32 v82, v82
v_exp_f32 v83, v83
v_exp_f32 v84, v84
v_exp_f32 v85, v85
v_mfma_f32_32x32x16_bf16 v[64:79], v[12:15], v[8:11], 0
v_exp_f32 v86, v86
v_exp_f32 v87, v87
v_cvt_pk_bf16_f32 v48, v80, v81
v_cvt_pk_bf16_f32 v49, v82, v83
v_cvt_pk_bf16_f32 v50, v84, v85
v_cvt_pk_bf16_f32 v51, v86, v87
v_exp_f32 v88, v88
v_exp_f32 v89, v89
v_mfma_f32_32x32x16_bf16 v[96:111], v[192:195], v[48:51], 0
v_exp_f32 v90, v90
v_exp_f32 v91, v91
v_exp_f32 v92, v92
v_exp_f32 v93, v93
v_exp_f32 v94, v94
v_exp_f32 v95, v95
v_cvt_pk_bf16_f32 v52, v88, v89
v_cvt_pk_bf16_f32 v53, v90, v91
v_cvt_pk_bf16_f32 v54, v92, v93
v_cvt_pk_bf16_f32 v55, v94, v95
v_exp_f32 v64, v64
v_exp_f32 v65, v65
v_mfma_f32_32x32x16_bf16 v[96:111], v[196:199], v[52:55], v[96:111]
v_exp_f32 v66, v66
v_exp_f32 v67, v67
v_exp_f32 v68, v68
v_exp_f32_e64 v69, v69
s_waitcnt lgkmcnt(0)
v_mfma_f32_32x32x16_bf16 v[80:95], v[16:19], v[4:7], 0
v_exp_f32 v70, v70
v_exp_f32 v71, v71
v_cvt_pk_bf16_f32 v48, v64, v65
v_cvt_pk_bf16_f32 v49, v66, v67
v_cvt_pk_bf16_f32 v50, v68, v69
v_cvt_pk_bf16_f32 v51, v70, v71
v_exp_f32 v72, v72
v_exp_f32 v73, v73
v_mfma_f32_32x32x16_bf16 v[112:127], v[192:195], v[48:51], v[112:127]
v_exp_f32 v74, v74
v_exp_f32 v75, v75
v_exp_f32 v76, v76
v_exp_f32 v77, v77
v_exp_f32 v78, v78
v_exp_f32 v79, v79
v_cvt_pk_bf16_f32 v52, v72, v73
v_cvt_pk_bf16_f32 v53, v74, v75
v_cvt_pk_bf16_f32 v54, v76, v77
v_cvt_pk_bf16_f32 v55, v78, v79
v_exp_f32 v80, v80
v_exp_f32 v81, v81
v_mfma_f32_32x32x16_bf16 v[112:127], v[196:199], v[52:55], v[112:127]
ds_read_b128 v[12:15], v216 offset:8192
s_mov_b64 exec, s[72:73]
ds_read_b128 v[192:195], v217 offset:8192
ds_read_b128 v[196:199], v217 offset:8704
s_mov_b64 exec, -1
v_exp_f32 v82, v82
v_exp_f32 v83, v83
v_exp_f32 v84, v84
v_exp_f32 v85, v85
v_mfma_f32_32x32x16_bf16 v[64:79], v[16:19], v[8:11], 0
v_exp_f32 v86, v86
v_exp_f32 v87, v87
v_cvt_pk_bf16_f32 v48, v80, v81
v_cvt_pk_bf16_f32 v49, v82, v83
v_cvt_pk_bf16_f32 v50, v84, v85
v_cvt_pk_bf16_f32 v51, v86, v87
v_exp_f32 v88, v88
v_exp_f32 v89, v89
v_mfma_f32_32x32x16_bf16 v[96:111], v[200:203], v[48:51], v[96:111]
v_exp_f32 v90, v90
v_exp_f32 v91, v91
v_exp_f32 v92, v92
v_exp_f32 v93, v93
v_exp_f32 v94, v94
v_exp_f32 v95, v95
v_cvt_pk_bf16_f32 v52, v88, v89
v_cvt_pk_bf16_f32 v53, v90, v91
v_cvt_pk_bf16_f32 v54, v92, v93
v_cvt_pk_bf16_f32 v55, v94, v95
s_waitcnt vmcnt(0)
v_mov_b32 v2, s10
v_mov_b32_e64 v3, s11
s_mov_b32 exec_hi, 0
s_mov_b32 exec_lo, 15
buffer_store_dwordx2 v[2:3], v214, s[40:43], s69 offen sc1
s_mov_b64 exec, -1
v_exp_f32 v64, v64
v_exp_f32_e64 v65, v65
v_mfma_f32_32x32x16_bf16 v[96:111], v[204:207], v[52:55], v[96:111]
v_exp_f32 v66, v66
v_exp_f32 v67, v67
v_exp_f32 v68, v68
v_exp_f32_e64 v69, v69
s_waitcnt lgkmcnt(0)
v_mfma_f32_32x32x16_bf16 v[80:95], v[12:15], v[4:7], 0
v_exp_f32 v70, v70
v_exp_f32 v71, v71
v_cvt_pk_bf16_f32 v48, v64, v65
v_cvt_pk_bf16_f32 v49, v66, v67
v_cvt_pk_bf16_f32 v50, v68, v69
v_cvt_pk_bf16_f32 v51, v70, v71
v_exp_f32 v72, v72
v_exp_f32 v73, v73
v_mfma_f32_32x32x16_bf16 v[112:127], v[200:203], v[48:51], v[112:127]
v_exp_f32 v74, v74
v_exp_f32 v75, v75
v_exp_f32 v76, v76
v_exp_f32 v77, v77
v_exp_f32 v78, v78
v_exp_f32 v79, v79
v_cvt_pk_bf16_f32 v52, v72, v73
v_cvt_pk_bf16_f32 v53, v74, v75
v_cvt_pk_bf16_f32 v54, v76, v77
v_cvt_pk_bf16_f32 v55, v78, v79
v_exp_f32 v80, v80
v_exp_f32 v81, v81
v_mfma_f32_32x32x16_bf16 v[112:127], v[204:207], v[52:55], v[112:127]
v_exp_f32 v82, v82
v_exp_f32 v83, v83
v_exp_f32 v84, v84
v_exp_f32 v85, v85
v_mfma_f32_32x32x16_bf16 v[64:79], v[12:15], v[8:11], 0
v_exp_f32 v86, v86
v_exp_f32 v87, v87
v_cvt_pk_bf16_f32 v48, v80, v81
v_cvt_pk_bf16_f32 v49, v82, v83
v_cvt_pk_bf16_f32 v50, v84, v85
v_cvt_pk_bf16_f32 v51, v86, v87
v_exp_f32 v88, v88
v_exp_f32 v89, v89
v_mfma_f32_32x32x16_bf16 v[96:111], v[192:195], v[48:51], v[96:111]
v_exp_f32 v90, v90
v_exp_f32 v91, v91
v_exp_f32 v92, v92
v_exp_f32 v93, v93
v_exp_f32 v94, v94
v_exp_f32 v95, v95
v_cvt_pk_bf16_f32 v52, v88, v89
v_cvt_pk_bf16_f32 v53, v90, v91
v_cvt_pk_bf16_f32 v54, v92, v93
v_cvt_pk_bf16_f32 v55, v94, v95
s_setprio 2
v_exp_f32 v64, v64
v_exp_f32_e64 v65, v65
v_mfma_f32_32x32x16_bf16 v[96:111], v[196:199], v[52:55], v[96:111]
s_cmp_eq_u32 s5, 0
s_cbranch_scc1 L_ns2
s_barrier
L_ns2:
ds_read_b128 v[16:19], v216 offset:7168
s_mov_b64 exec, s[72:73]
ds_read_b128 v[200:203], v217 offset:7168
ds_read_b128 v[204:207], v217 offset:7680
s_mov_b64 exec, -1
v_exp_f32 v66, v66
v_exp_f32 v67, v67
v_exp_f32 v68, v68
v_exp_f32 v69, v69
v_exp_f32 v70, v70
v_exp_f32_e64 v71, v71
v_cvt_pk_bf16_f32 v48, v64, v65
v_cvt_pk_bf16_f32 v49, v66, v67
v_cvt_pk_bf16_f32 v50, v68, v69
v_cvt_pk_bf16_f32 v51, v70, v71
s_waitcnt lgkmcnt(0)
v_mfma_f32_32x32x16_bf16 v[80:95], v[16:19], v[4:7], 0
v_exp_f32 v72, v72
v_exp_f32 v73, v73
v_exp_f32 v74, v74
v_exp_f32_e64 v75, v75
v_mfma_f32_32x32x16_bf16 v[112:127], v[192:195], v[48:51], v[112:127]
v_exp_f32 v76, v76
v_exp_f32 v77, v77
v_exp_f32 v78, v78
v_exp_f32 v79, v79
v_cvt_pk_bf16_f32 v52, v72, v73
v_cvt_pk_bf16_f32 v53, v74, v75
v_cvt_pk_bf16_f32 v54, v76, v77
v_cvt_pk_bf16_f32 v55, v78, v79
s_cmp_eq_u32 s5, 0
s_cbranch_scc1 L_exit2_7
v_exp_f32 v80, v80
v_exp_f32 v81, v81
v_mfma_f32_32x32x16_bf16 v[112:127], v[196:199], v[52:55], v[112:127]
ds_read_b128 v[12:15], v216 offset:6144
s_mov_b64 exec, s[72:73]
ds_read_b128 v[192:195], v217 offset:6144
ds_read_b128 v[196:199], v217 offset:6656
s_mov_b64 exec, -1
v_exp_f32 v82, v82
v_exp_f32 v83, v83
v_exp_f32 v84, v84
v_exp_f32 v85, v85
v_mfma_f32_32x32x16_bf16 v[64:79], v[16:19], v[8:11], 0
v_exp_f32 v86, v86
v_exp_f32 v87, v87
v_cvt_pk_bf16_f32 v48, v80, v81
v_cvt_pk_bf16_f32 v49, v82, v83
v_cvt_pk_bf16_f32 v50, v84, v85
v_cvt_pk_bf16_f32 v51, v86, v87
v_exp_f32 v88, v88
v_exp_f32 v89, v89
v_mfma_f32_32x32x16_bf16 v[96:111], v[200:203], v[48:51], v[96:111]
v_exp_f32 v90, v90
v_exp_f32 v91, v91
v_exp_f32 v92, v92
v_exp_f32 v93, v93
v_exp_f32 v94, v94
v_exp_f32 v95, v95
v_cvt_pk_bf16_f32 v52, v88, v89
v_cvt_pk_bf16_f32 v53, v90, v91
v_cvt_pk_bf16_f32 v54, v92, v93
v_cvt_pk_bf16_f32 v55, v94, v95
v_exp_f32 v64, v64
v_exp_f32 v65, v65
v_mfma_f32_32x32x16_bf16 v[96:111], v[204:207], v[52:55], v[96:111]
v_exp_f32 v66, v66
v_exp_f32 v67, v67
v_exp_f32 v68, v68
v_exp_f32_e64 v69, v69
s_waitcnt lgkmcnt(0)
v_mfma_f32_32x32x16_bf16 v[80:95], v[12:15], v[4:7], 0
v_exp_f32 v70, v70
v_exp_f32 v71, v71
v_cvt_pk_bf16_f32 v48, v64, v65
v_cvt_pk_bf16_f32 v49, v66, v67
v_cvt_pk_bf16_f32 v50, v68, v69
v_cvt_pk_bf16_f32 v51, v70, v71
v_exp_f32 v72, v72
v_exp_f32 v73, v73
v_mfma_f32_32x32x16_bf16 v[112:127], v[200:203], v[48:51], v[112:127]
v_exp_f32 v74, v74
v_exp_f32 v75, v75
v_exp_f32 v76, v76
v_exp_f32 v77, v77
v_exp_f32 v78, v78
v_exp_f32 v79, v79
v_cvt_pk_bf16_f32 v52, v72, v73
v_cvt_pk_bf16_f32 v53, v74, v75
v_cvt_pk_bf16_f32 v54, v76, v77
v_cvt_pk_bf16_f32 v55, v78, v79
v_exp_f32 v80, v80
v_exp_f32 v81, v81
v_mfma_f32_32x32x16_bf16 v[112:127], v[204:207], v[52:55], v[112:127]
v_exp_f32 v82, v82
v_exp_f32 v83, v83
v_exp_f32 v84, v84
v_exp_f32 v85, v85
v_mfma_f32_32x32x16_bf16 v[64:79], v[12:15], v[8:11], 0
v_exp_f32 v86, v86
v_exp_f32 v87, v87
v_cvt_pk_bf16_f32 v48, v80, v81
v_cvt_pk_bf16_f32 v49, v82, v83
v_cvt_pk_bf16_f32 v50, v84, v85
v_cvt_pk_bf16_f32 v51, v86, v87
v_exp_f32 v88, v88
v_exp_f32 v89, v89
v_mfma_f32_32x32x16_bf16 v[96:111], v[192:195], v[48:51], v[96:111]
v_exp_f32 v90, v90
v_exp_f32 v91, v91
v_exp_f32 v92, v92
v_exp_f32 v93, v93
v_exp_f32 v94, v94
v_exp_f32 v95, v95
v_cvt_pk_bf16_f32 v52, v88, v89
v_cvt_pk_bf16_f32 v53, v90, v91
v_cvt_pk_bf16_f32 v54, v92, v93
v_cvt_pk_bf16_f32 v55, v94, v95
v_exp_f32 v64, v64
v_exp_f32 v65, v65
v_mfma_f32_32x32x16_bf16 v[96:111], v[196:199], v[52:55], v[96:111]
s_barrier
ds_read_b128 v[16:19], v216 offset:5120
s_mov_b64 exec, s[72:73]
ds_read_b128 v[200:203], v217 offset:5120
ds_read_b128 v[204:207], v217 offset:5632
s_mov_b64 exec, -1
v_exp_f32 v66, v66
v_exp_f32 v67, v67
v_exp_f32 v68, v68
v_exp_f32 v69, v69
v_exp_f32 v70, v70
v_exp_f32_e64 v71, v71
v_cvt_pk_bf16_f32 v48, v64, v65
v_cvt_pk_bf16_f32 v49, v66, v67
v_cvt_pk_bf16_f32 v50, v68, v69
v_cvt_pk_bf16_f32 v51, v70, v71
s_waitcnt lgkmcnt(0)
v_mfma_f32_32x32x16_bf16 v[80:95], v[16:19], v[4:7], 0
v_exp_f32 v72, v72
v_exp_f32 v73, v73
v_exp_f32 v74, v74
v_exp_f32_e64 v75, v75
v_mfma_f32_32x32x16_bf16 v[112:127], v[192:195], v[48:51], v[112:127]
v_exp_f32 v76, v76
v_exp_f32 v77, v77
v_exp_f32 v78, v78
v_exp_f32 v79, v79
v_cvt_pk_bf16_f32 v52, v72, v73
v_cvt_pk_bf16_f32 v53, v74, v75
v_cvt_pk_bf16_f32 v54, v76, v77
v_cvt_pk_bf16_f32 v55, v78, v79
v_exp_f32 v80, v80
v_exp_f32 v81, v81
v_mfma_f32_32x32x16_bf16 v[112:127], v[196:199], v[52:55], v[112:127]
ds_read_b128 v[12:15], v216 offset:4096
s_mov_b64 exec, s[72:73]
ds_read_b128 v[192:195], v217 offset:4096
ds_read_b128 v[196:199], v217 offset:4608
s_mov_b64 exec, -1
v_exp_f32 v82, v82
v_exp_f32 v83, v83
v_exp_f32 v84, v84
v_exp_f32 v85, v85
v_mfma_f32_32x32x16_bf16 v[64:79], v[16:19], v[8:11], 0
v_exp_f32 v86, v86
v_exp_f32 v87, v87
v_cvt_pk_bf16_f32 v48, v80, v81
v_cvt_pk_bf16_f32 v49, v82, v83
v_cvt_pk_bf16_f32 v50, v84, v85
v_cvt_pk_bf16_f32 v51, v86, v87
v_exp_f32 v88, v88
v_exp_f32 v89, v89
v_mfma_f32_32x32x16_bf16 v[96:111], v[200:203], v[48:51], v[96:111]
v_exp_f32 v90, v90
v_exp_f32 v91, v91
v_exp_f32 v92, v92
v_exp_f32 v93, v93
v_exp_f32 v94, v94
v_exp_f32 v95, v95
v_cvt_pk_bf16_f32 v52, v88, v89
v_cvt_pk_bf16_f32 v53, v90, v91
v_cvt_pk_bf16_f32 v54, v92, v93
v_cvt_pk_bf16_f32 v55, v94, v95
v_exp_f32 v64, v64
v_exp_f32 v65, v65
v_mfma_f32_32x32x16_bf16 v[96:111], v[204:207], v[52:55], v[96:111]
v_exp_f32 v66, v66
v_exp_f32 v67, v67
v_exp_f32 v68, v68
v_exp_f32_e64 v69, v69
s_waitcnt lgkmcnt(0)
v_mfma_f32_32x32x16_bf16 v[80:95], v[12:15], v[4:7], 0
v_exp_f32 v70, v70
v_exp_f32 v71, v71
v_cvt_pk_bf16_f32 v48, v64, v65
v_cvt_pk_bf16_f32 v49, v66, v67
v_cvt_pk_bf16_f32 v50, v68, v69
v_cvt_pk_bf16_f32 v51, v70, v71
v_exp_f32 v72, v72
v_exp_f32 v73, v73
v_mfma_f32_32x32x16_bf16 v[112:127], v[200:203], v[48:51], v[112:127]
v_exp_f32 v74, v74
v_exp_f32 v75, v75
v_exp_f32 v76, v76
v_exp_f32 v77, v77
v_exp_f32 v78, v78
v_exp_f32 v79, v79
v_cvt_pk_bf16_f32 v52, v72, v73
v_cvt_pk_bf16_f32 v53, v74, v75
v_cvt_pk_bf16_f32 v54, v76, v77
v_cvt_pk_bf16_f32 v55, v78, v79
v_exp_f32 v80, v80
v_exp_f32 v81, v81
v_mfma_f32_32x32x16_bf16 v[112:127], v[204:207], v[52:55], v[112:127]
s_barrier
ds_read_b128 v[16:19], v216 offset:3072
s_mov_b64 exec, s[72:73]
ds_read_b128 v[200:203], v217 offset:3072
ds_read_b128 v[204:207], v217 offset:3584
s_mov_b64 exec, -1
v_exp_f32 v82, v82
v_exp_f32 v83, v83
v_exp_f32 v84, v84
v_exp_f32_e64 v85, v85
v_mfma_f32_32x32x16_bf16 v[64:79], v[12:15], v[8:11], 0
v_exp_f32 v86, v86
v_exp_f32 v87, v87
v_cvt_pk_bf16_f32 v48, v80, v81
v_cvt_pk_bf16_f32 v49, v82, v83
v_cvt_pk_bf16_f32 v50, v84, v85
v_cvt_pk_bf16_f32 v51, v86, v87
v_exp_f32 v88, v88
v_exp_f32 v89, v89
v_mfma_f32_32x32x16_bf16 v[96:111], v[192:195], v[48:51], v[96:111]
v_exp_f32 v90, v90
v_exp_f32 v91, v91
v_exp_f32 v92, v92
v_exp_f32 v93, v93
v_exp_f32 v94, v94
v_exp_f32 v95, v95
v_cvt_pk_bf16_f32 v52, v88, v89
v_cvt_pk_bf16_f32 v53, v90, v91
v_cvt_pk_bf16_f32 v54, v92, v93
v_cvt_pk_bf16_f32 v55, v94, v95
v_exp_f32 v64, v64
v_exp_f32 v65, v65
v_mfma_f32_32x32x16_bf16 v[96:111], v[196:199], v[52:55], v[96:111]
v_exp_f32 v66, v66
v_exp_f32 v67, v67
v_exp_f32 v68, v68
v_exp_f32_e64 v69, v69
s_waitcnt lgkmcnt(0)
v_mfma_f32_32x32x16_bf16 v[80:95], v[16:19], v[4:7], 0
v_exp_f32 v70, v70
v_exp_f32 v71, v71
v_cvt_pk_bf16_f32 v48, v64, v65
v_cvt_pk_bf16_f32 v49, v66, v67
v_cvt_pk_bf16_f32 v50, v68, v69
v_cvt_pk_bf16_f32 v51, v70, v71
v_exp_f32 v72, v72
v_exp_f32 v73, v73
v_mfma_f32_32x32x16_bf16 v[112:127], v[192:195], v[48:51], v[112:127]
v_exp_f32 v74, v74
v_exp_f32 v75, v75
v_exp_f32 v76, v76
v_exp_f32 v77, v77
v_exp_f32 v78, v78
v_exp_f32 v79, v79
v_cvt_pk_bf16_f32 v52, v72, v73
v_cvt_pk_bf16_f32 v53, v74, v75
v_cvt_pk_bf16_f32 v54, v76, v77
v_cvt_pk_bf16_f32 v55, v78, v79
s_cmp_eq_u32 s5, 1
s_cbranch_scc1 L_exit2_3
v_exp_f32 v80, v80
v_exp_f32 v81, v81
v_mfma_f32_32x32x16_bf16 v[112:127], v[196:199], v[52:55], v[112:127]
ds_read_b128 v[12:15], v216 offset:2048
s_mov_b64 exec, s[72:73]
ds_read_b128 v[192:195], v217 offset:2048
ds_read_b128 v[196:199], v217 offset:2560
s_mov_b64 exec, -1
v_exp_f32 v82, v82
v_exp_f32 v83, v83
v_exp_f32 v84, v84
v_exp_f32 v85, v85
v_mfma_f32_32x32x16_bf16 v[64:79], v[16:19], v[8:11], v[240:255]
v_exp_f32 v86, v86
v_exp_f32 v87, v87
v_cvt_pk_bf16_f32 v48, v80, v81
v_cvt_pk_bf16_f32 v49, v82, v83
v_cvt_pk_bf16_f32 v50, v84, v85
v_cvt_pk_bf16_f32 v51, v86, v87
v_exp_f32 v88, v88
v_exp_f32 v89, v89
v_mfma_f32_32x32x16_bf16 v[96:111], v[200:203], v[48:51], v[96:111]
v_exp_f32 v90, v90
v_exp_f32 v91, v91
v_exp_f32 v92, v92
v_exp_f32 v93, v93
v_exp_f32 v94, v94
v_exp_f32 v95, v95
v_cvt_pk_bf16_f32 v52, v88, v89
v_cvt_pk_bf16_f32 v53, v90, v91
v_cvt_pk_bf16_f32 v54, v92, v93
v_cvt_pk_bf16_f32 v55, v94, v95
v_exp_f32 v64, v64
v_exp_f32 v65, v65
v_mfma_f32_32x32x16_bf16 v[96:111], v[204:207], v[52:55], v[96:111]
v_exp_f32 v66, v66
v_exp_f32 v67, v67
v_exp_f32 v68, v68
v_exp_f32_e64 v69, v69
s_waitcnt lgkmcnt(0)
v_mfma_f32_32x32x16_bf16 v[80:95], v[12:15], v[4:7], v[240:255]
v_exp_f32 v70, v70
v_exp_f32 v71, v71
v_cvt_pk_bf16_f32 v48, v64, v65
v_cvt_pk_bf16_f32 v49, v66, v67
v_cvt_pk_bf16_f32 v50, v68, v69
v_cvt_pk_bf16_f32 v51, v70, v71
v_exp_f32 v72, v72
v_exp_f32 v73, v73
v_mfma_f32_32x32x16_bf16 v[112:127], v[200:203], v[48:51], v[112:127]
v_exp_f32 v74, v74
v_exp_f32 v75, v75
v_exp_f32 v76, v76
v_exp_f32 v77, v77
v_exp_f32 v78, v78
v_exp_f32 v79, v79
v_cvt_pk_bf16_f32 v52, v72, v73
v_cvt_pk_bf16_f32 v53, v74, v75
v_cvt_pk_bf16_f32 v54, v76, v77
v_cvt_pk_bf16_f32 v55, v78, v79
v_exp_f32 v80, v80
v_exp_f32 v81, v81
v_mfma_f32_32x32x16_bf16 v[112:127], v[204:207], v[52:55], v[112:127]
v_exp_f32 v82, v82
v_exp_f32 v83, v83
v_exp_f32 v84, v84
v_exp_f32 v85, v85
v_exp_f32 v86, v86
v_exp_f32 v87, v87
v_cvt_pk_bf16_f32 v48, v80, v81
v_cvt_pk_bf16_f32 v49, v82, v83
v_cvt_pk_bf16_f32 v50, v84, v85
v_cvt_pk_bf16_f32 v51, v86, v87
v_exp_f32 v88, v88
v_exp_f32 v89, v89
v_mfma_f32_32x32x16_bf16 v[96:111], v[192:195], v[48:51], v[96:111]
v_exp_f32 v90, v90
v_exp_f32 v91, v91
v_exp_f32 v92, v92
v_exp_f32 v93, v93
v_exp_f32 v94, v94
v_exp_f32 v95, v95
v_cvt_pk_bf16_f32 v52, v88, v89
v_cvt_pk_bf16_f32 v53, v90, v91
v_cvt_pk_bf16_f32 v54, v92, v93
v_cvt_pk_bf16_f32 v55, v94, v95
s_nop 1
v_mfma_f32_32x32x16_bf16 v[96:111], v[196:199], v[52:55], v[96:111]
s_branch L_finB
L_helpB:
s_mov_b32 s42, 13631488
s_mov_b32 s44, s28
s_mov_b32 s45, s29
s_mov_b32 s46, 4194304
s_mov_b32 s47, 0x20000
s_mov_b32 s72, 0xffff
s_mov_b32 s73, 0xffff
s_lshr_b32 s56, s8, 1
s_lshl_b32 s56, s56, 3
s_and_b32 s12, s9, 7
s_add_u32 s12, s12, s56
s_lshl_b32 s13, s8, 2
s_and_b32 s56, s9, 3
s_add_u32 s13, s13, s56
s_lshl_b32 s7, s13, 5
s_and_b32 s56, s9, 28
s_add_u32 s7, s7, s56
s_add_u32 s7, s7, s14
s_lshl_b32 s7, s7, 7
s_add_u32 s7, s7, 262144
s_lshl_b32 s56, s12, 3
s_lshr_b32 s57, s9, 3
s_add_u32 s56, s56, s57
s_add_u32 s56, s56, 256
s_lshl_b32 s57, s5, 3
s_add_u32 s57, s57, s6
s_add_u32 s57, s57, 8
s_cmp_eq_u32 s4, 0
s_cselect_b32 s56, s56, s57
s_lshl_b32 s56, s56, 2
s_add_u32 s56, s56, s14
s_lshl_b32 s15, s56, 7
s_mov_b32 s56, 0x3f803f80
s_mov_b32 s57, s56
v_mov_b64 v[192:193], s[56:57]
v_mov_b64 v[194:195], s[56:57]
v_mov_b64 v[196:197], s[56:57]
v_mov_b64 v[198:199], s[56:57]
v_mov_b64 v[200:201], s[56:57]
v_mov_b64 v[202:203], s[56:57]
v_mov_b64 v[204:205], s[56:57]
v_mov_b64_e64 v[206:207], s[56:57]
s_waitcnt lgkmcnt(0)
s_mul_i32 s10, s10, 0x9e3779b1
s_add_u32 s10, s10, 0x7f4a7c15
s_mul_i32 s11, s11, 0x2c9277b5
s_add_u32 s11, s11, 0xac564b05
s_xor_b32 s11, s11, s10
s_mul_i32 s58, s14, 12288
v_add_u32 v216, s58, v208
s_add_u32 s56, s58, 49152
v_add_u32_e64 v217, s56, v209
s_mov_b32 s55, 0
s_lshl_b32 s56, s5, 2
s_add_u32 s56, s56, 0
s_lshl_b32 s57, s56, 3
s_add_u32 s57, s57, s6
s_lshl_b32 s57, s57, 2
s_add_u32 s57, s57, s14
s_lshl_b32 s57, s57, 10
s_add_u32 s70, s57, 8388608
s_add_u32 s71, s70, 32768
s_lshl_b32 s68, s5, 6
s_lshr_b32 s56, s6, 2
s_lshl_b32 s56, s56, 1
s_add_u32 s68, s68, s56
s_lshl_b32 s68, s68, 4
s_and_b32 s56, s6, 3
s_add_u32 s68, s68, s56
s_lshl_b32 s68, s68, 3
s_add_u32 s68, s68, 262144
v_lshrrev_b32 v2, 1, v1
v_and_b32 v3, 1, v1
v_lshlrev_b32_e64 v3, 7, v3
v_lshl_add_u32 v214, v2, 9, v3
s_lshl_b32 s56, s6, 2
s_add_u32 s56, s56, s14
s_lshl_b32 s56, s56, 6
s_lshl_b32 s57, s5, 2
s_add_u32 s56, s56, s57
s_lshl_b32 s56, s56, 10
s_add_u32 s64, s56, 2093056
s_add_u32 s65, s56, 4190208
s_add_u32 s66, s58, 4096
s_add_u32 s67, s58, 53248
s_waitcnt vmcnt(0)
s_barrier
s_setprio 1
ds_read_b128 v[4:7], v216
ds_read_b128 v[8:11], v216 offset:1024
ds_read_b128 v[16:19], v216 offset:9216
s_mov_b64 exec, s[72:73]
ds_read_b128 v[200:203], v217 offset:9216
ds_read_b128 v[204:207], v217 offset:9728
s_mov_b64 exec, -1
ds_read_b128 v[12:15], v216 offset:8192
s_mov_b64 exec, s[72:73]
ds_read_b128 v[192:195], v217 offset:8192
ds_read_b128 v[196:199], v217 offset:8704
s_mov_b64 exec, -1
s_waitcnt lgkmcnt(5)
v_mfma_f32_32x32x16_bf16 v[64:79], v[16:19], v[8:11], v[224:239]
s_waitcnt lgkmcnt(0)
s_nop 7
s_nop 2
v_exp_f32 v64, v64
v_exp_f32 v65, v65
v_exp_f32 v66, v66
v_exp_f32 v67, v67
v_exp_f32 v68, v68
v_exp_f32_e64 v69, v69
v_mfma_f32_32x32x16_bf16 v[80:95], v[12:15], v[4:7], v[224:239]
v_exp_f32 v70, v70
v_exp_f32 v71, v71
v_cvt_pk_bf16_f32 v48, v64, v65
v_cvt_pk_bf16_f32 v49, v66, v67
v_cvt_pk_bf16_f32 v50, v68, v69
v_cvt_pk_bf16_f32 v51, v70, v71
v_exp_f32 v72, v72
v_exp_f32 v73, v73
v_mfma_f32_32x32x16_bf16 v[112:127], v[200:203], v[48:51], 0
v_exp_f32 v74, v74
v_exp_f32 v75, v75
v_exp_f32 v76, v76
v_exp_f32 v77, v77
v_exp_f32 v78, v78
v_exp_f32 v79, v79
v_cvt_pk_bf16_f32 v52, v72, v73
v_cvt_pk_bf16_f32 v53, v74, v75
v_cvt_pk_bf16_f32 v54, v76, v77
v_cvt_pk_bf16_f32 v55, v78, v79
v_exp_f32 v80, v80
v_exp_f32 v81, v81
v_mfma_f32_32x32x16_bf16 v[112:127], v[204:207], v[52:55], v[112:127]
v_exp_f32 v82, v82
v_exp_f32 v83, v83
v_exp_f32 v84, v84
v_exp_f32 v85, v85
v_mfma_f32_32x32x16_bf16 v[64:79], v[12:15], v[8:11], 0
v_exp_f32 v86, v86
v_exp_f32 v87, v87
v_cvt_pk_bf16_f32 v48, v80, v81
v_cvt_pk_bf16_f32 v49, v82, v83
v_cvt_pk_bf16_f32 v50, v84, v85
v_cvt_pk_bf16_f32 v51, v86, v87
v_exp_f32 v88, v88
v_exp_f32 v89, v89
v_mfma_f32_32x32x16_bf16 v[96:111], v[192:195], v[48:51], 0
v_exp_f32 v90, v90
v_exp_f32 v91, v91
v_exp_f32 v92, v92
v_exp_f32 v93, v93
v_exp_f32 v94, v94
v_exp_f32 v95, v95
v_cvt_pk_bf16_f32 v52, v88, v89
v_cvt_pk_bf16_f32 v53, v90, v91
v_cvt_pk_bf16_f32 v54, v92, v93
v_cvt_pk_bf16_f32 v55, v94, v95
v_exp_f32 v64, v64
v_exp_f32 v65, v65
v_mfma_f32_32x32x16_bf16 v[96:111], v[196:199], v[52:55], v[96:111]
s_cmp_eq_u32 s5, 0
s_cbranch_scc1 L_ns0
s_mov_b32 s74, 4194304
L_pk1:
L_pk1_f:
s_load_dwordx4 s[24:27], s[40:41], s15 offset:32 glc
L_pk1_w:
s_sub_u32 s74, s74, 1
s_waitcnt lgkmcnt(0)
s_cbranch_scc1 L_pk1_d
L_pk1_c:
s_cmp_eq_u64 s[24:25], s[10:11]
s_cbranch_scc0 L_pk1
s_cmp_eq_u64 s[26:27], s[10:11]
s_cbranch_scc0 L_pk1
L_pk1_d:
s_mov_b32 m0, s66
s_nop 0
buffer_load_dwordx4 v208, s[40:43], s64 offen offset:3072 sc1 lds
buffer_load_dwordx4 v208, s[40:43], s64 offen offset:2048 sc1 lds
s_mov_b32 m0, s67
s_nop 0
buffer_load_dwordx4 v208, s[40:43], s65 offen offset:3072 sc1 lds
buffer_load_dwordx4 v208, s[40:43], s65 offen offset:2048 sc1 lds
s_waitcnt vmcnt(2)
s_load_dwordx8 s[16:23], s[40:41], s15 glc
s_waitcnt vmcnt(0)
s_barrier
s_mov_b32 s74, 4194304
s_branch L_pk2_w
L_pk2:
L_pk2_f:
s_load_dwordx8 s[16:23], s[40:41], s15 offset:0 glc
L_pk2_w:
s_sub_u32 s74, s74, 1
s_waitcnt lgkmcnt(0)
s_cbranch_scc1 L_pk2_d
L_pk2_c:
s_cmp_eq_u64 s[16:17], s[10:11]
s_cbranch_scc0 L_pk2
s_cmp_eq_u64 s[18:19], s[10:11]
s_cbranch_scc0 L_pk2
L_pk2_d:
s_mov_b32 m0, s66
s_nop 0
buffer_load_dwordx4 v208, s[40:43], s64 offen offset:1024 sc1 lds
buffer_load_dwordx4 v208, s[40:43], s64 offen offset:0 sc1 lds
s_mov_b32 m0, s67
s_nop 0
buffer_load_dwordx4 v208, s[40:43], s65 offen offset:1024 sc1 lds
buffer_load_dwordx4 v208, s[40:43], s65 offen offset:0 sc1 lds
s_cmp_eq_u32 s5, 1
s_cbranch_scc1 L_ns0
s_sub_u32 s64, s64, 4096
s_sub_u32 s65, s65, 4096
s_sub_u32 s66, s66, 4096
s_sub_u32 s67, s67, 4096
s_mov_b32 s74, 4194304
s_branch L_pk3_c
L_pk3:
L_pk3_f:
s_load_dwordx8 s[16:23], s[40:41], s15 offset:0 glc
L_pk3_w:
s_sub_u32 s74, s74, 1
s_waitcnt lgkmcnt(0)
s_cbranch_scc1 L_pk3_d
L_pk3_c:
s_cmp_eq_u64 s[20:21], s[10:11]
s_cbranch_scc0 L_pk3
s_cmp_eq_u64 s[22:23], s[10:11]
s_cbranch_scc0 L_pk3
L_pk3_d:
s_mov_b32 m0, s66
s_nop 0
buffer_load_dwordx4 v208, s[40:43], s64 offen offset:3072 sc1 lds
buffer_load_dwordx4 v208, s[40:43], s64 offen offset:2048 sc1 lds
buffer_load_dwordx4 v208, s[40:43], s64 offen offset:1024 sc1 lds
buffer_load_dwordx4 v208, s[40:43], s64 offen offset:0 sc1 lds
s_mov_b32 m0, s67
s_nop 0
buffer_load_dwordx4 v208, s[40:43], s65 offen offset:3072 sc1 lds
buffer_load_dwordx4 v208, s[40:43], s65 offen offset:2048 sc1 lds
buffer_load_dwordx4 v208, s[40:43], s65 offen offset:1024 sc1 lds
buffer_load_dwordx4 v208, s[40:43], s65 offen offset:0 sc1 lds
L_ns0:
s_setprio 1
ds_read_b128 v[16:19], v216 offset:7168
s_mov_b64 exec, s[72:73]
ds_read_b128 v[200:203], v217 offset:7168
ds_read_b128 v[204:207], v217 offset:7680
s_mov_b64 exec, -1
v_exp_f32 v66, v66
v_exp_f32 v67, v67
v_exp_f32 v68, v68
v_exp_f32 v69, v69
v_exp_f32 v70, v70
v_exp_f32_e64 v71, v71
v_cvt_pk_bf16_f32 v48, v64, v65
v_cvt_pk_bf16_f32 v49, v66, v67
v_cvt_pk_bf16_f32 v50, v68, v69
v_cvt_pk_bf16_f32 v51, v70, v71
s_waitcnt lgkmcnt(0)
v_mfma_f32_32x32x16_bf16 v[80:95], v[16:19], v[4:7], 0
v_exp_f32 v72, v72
v_exp_f32 v73, v73
v_exp_f32 v74, v74
v_exp_f32_e64 v75, v75
v_mfma_f32_32x32x16_bf16 v[112:127], v[192:195], v[48:51], v[112:127]
v_exp_f32 v76, v76
v_exp_f32 v77, v77
v_exp_f32 v78, v78
v_exp_f32 v79, v79
v_cvt_pk_bf16_f32 v52, v72, v73
v_cvt_pk_bf16_f32 v53, v74, v75
v_cvt_pk_bf16_f32 v54, v76, v77
v_cvt_pk_bf16_f32 v55, v78, v79
s_cmp_eq_u32 s5, 0
s_cbranch_scc1 L_exit0_7
v_exp_f32 v80, v80
v_exp_f32 v81, v81
v_mfma_f32_32x32x16_bf16 v[112:127], v[196:199], v[52:55], v[112:127]
ds_read_b128 v[12:15], v216 offset:6144
s_mov_b64 exec, s[72:73]
ds_read_b128 v[192:195], v217 offset:6144
ds_read_b128 v[196:199], v217 offset:6656
s_mov_b64 exec, -1
v_exp_f32 v82, v82
v_exp_f32 v83, v83
v_exp_f32 v84, v84
v_exp_f32 v85, v85
v_mfma_f32_32x32x16_bf16 v[64:79], v[16:19], v[8:11], 0
v_exp_f32 v86, v86
v_exp_f32 v87, v87
v_cvt_pk_bf16_f32 v48, v80, v81
v_cvt_pk_bf16_f32 v49, v82, v83
v_cvt_pk_bf16_f32 v50, v84, v85
v_cvt_pk_bf16_f32 v51, v86, v87
v_exp_f32 v88, v88
v_exp_f32 v89, v89
v_mfma_f32_32x32x16_bf16 v[96:111], v[200:203], v[48:51], v[96:111]
v_exp_f32 v90, v90
v_exp_f32 v91, v91
v_exp_f32 v92, v92
v_exp_f32 v93, v93
v_exp_f32 v94, v94
v_exp_f32 v95, v95
v_cvt_pk_bf16_f32 v52, v88, v89
v_cvt_pk_bf16_f32 v53, v90, v91
v_cvt_pk_bf16_f32 v54, v92, v93
v_cvt_pk_bf16_f32 v55, v94, v95
v_exp_f32 v64, v64
v_exp_f32 v65, v65
v_mfma_f32_32x32x16_bf16 v[96:111], v[204:207], v[52:55], v[96:111]
v_exp_f32 v66, v66
v_exp_f32 v67, v67
v_exp_f32 v68, v68
v_exp_f32_e64 v69, v69
s_waitcnt lgkmcnt(0)
v_mfma_f32_32x32x16_bf16 v[80:95], v[12:15], v[4:7], 0
v_exp_f32 v70, v70
v_exp_f32 v71, v71
v_cvt_pk_bf16_f32 v48, v64, v65
v_cvt_pk_bf16_f32 v49, v66, v67
v_cvt_pk_bf16_f32 v50, v68, v69
v_cvt_pk_bf16_f32 v51, v70, v71
v_exp_f32 v72, v72
v_exp_f32 v73, v73
v_mfma_f32_32x32x16_bf16 v[112:127], v[200:203], v[48:51], v[112:127]
v_exp_f32 v74, v74
v_exp_f32 v75, v75
v_exp_f32 v76, v76
v_exp_f32 v77, v77
v_exp_f32 v78, v78
v_exp_f32 v79, v79
v_cvt_pk_bf16_f32 v52, v72, v73
v_cvt_pk_bf16_f32 v53, v74, v75
v_cvt_pk_bf16_f32 v54, v76, v77
v_cvt_pk_bf16_f32 v55, v78, v79
v_exp_f32 v80, v80
v_exp_f32 v81, v81
v_mfma_f32_32x32x16_bf16 v[112:127], v[204:207], v[52:55], v[112:127]
v_exp_f32 v82, v82
v_exp_f32 v83, v83
v_exp_f32 v84, v84
v_exp_f32 v85, v85
v_mfma_f32_32x32x16_bf16 v[64:79], v[12:15], v[8:11], 0
v_exp_f32 v86, v86
v_exp_f32 v87, v87
v_cvt_pk_bf16_f32 v48, v80, v81
v_cvt_pk_bf16_f32 v49, v82, v83
v_cvt_pk_bf16_f32 v50, v84, v85
v_cvt_pk_bf16_f32 v51, v86, v87
v_exp_f32 v88, v88
v_exp_f32 v89, v89
v_mfma_f32_32x32x16_bf16 v[96:111], v[192:195], v[48:51], v[96:111]
v_exp_f32 v90, v90
v_exp_f32 v91, v91
v_exp_f32 v92, v92
v_exp_f32 v93, v93
v_exp_f32 v94, v94
v_exp_f32 v95, v95
v_cvt_pk_bf16_f32 v52, v88, v89
v_cvt_pk_bf16_f32 v53, v90, v91
v_cvt_pk_bf16_f32 v54, v92, v93
v_cvt_pk_bf16_f32 v55, v94, v95
v_exp_f32 v64, v64
v_exp_f32 v65, v65
v_mfma_f32_32x32x16_bf16 v[96:111], v[196:199], v[52:55], v[96:111]
s_cmp_eq_u32 s5, 1
s_cbranch_scc1 L_w50
s_waitcnt vmcnt(8)
s_branch L_w51
L_w50:
s_waitcnt vmcnt(0)
L_w51:
s_barrier
ds_read_b128 v[16:19], v216 offset:5120
s_mov_b64 exec, s[72:73]
ds_read_b128 v[200:203], v217 offset:5120
ds_read_b128 v[204:207], v217 offset:5632
s_mov_b64 exec, -1
v_exp_f32 v66, v66
v_exp_f32 v67, v67
v_exp_f32 v68, v68
v_exp_f32 v69, v69
v_exp_f32 v70, v70
v_exp_f32 v71, v71
v_cvt_pk_bf16_f32 v48, v64, v65
v_cvt_pk_bf16_f32 v49, v66, v67
v_cvt_pk_bf16_f32 v50, v68, v69
v_cvt_pk_bf16_f32 v51, v70, v71
s_waitcnt lgkmcnt(0)
v_mfma_f32_32x32x16_bf16 v[80:95], v[16:19], v[4:7], 0
v_exp_f32 v72, v72
v_exp_f32 v73, v73
v_exp_f32 v74, v74
v_exp_f32_e64 v75, v75
v_mfma_f32_32x32x16_bf16 v[112:127], v[192:195], v[48:51], v[112:127]
v_exp_f32 v76, v76
v_exp_f32 v77, v77
v_exp_f32 v78, v78
v_exp_f32 v79, v79
v_cvt_pk_bf16_f32 v52, v72, v73
v_cvt_pk_bf16_f32 v53, v74, v75
v_cvt_pk_bf16_f32 v54, v76, v77
v_cvt_pk_bf16_f32 v55, v78, v79
v_exp_f32 v80, v80
v_exp_f32 v81, v81
v_mfma_f32_32x32x16_bf16 v[112:127], v[196:199], v[52:55], v[112:127]
ds_read_b128 v[12:15], v216 offset:4096
s_mov_b64 exec, s[72:73]
ds_read_b128 v[192:195], v217 offset:4096
ds_read_b128 v[196:199], v217 offset:4608
s_mov_b64 exec, -1
v_exp_f32 v82, v82
v_exp_f32 v83, v83
v_exp_f32 v84, v84
v_exp_f32 v85, v85
v_mfma_f32_32x32x16_bf16 v[64:79], v[16:19], v[8:11], 0
v_exp_f32 v86, v86
v_exp_f32 v87, v87
v_cvt_pk_bf16_f32 v48, v80, v81
v_cvt_pk_bf16_f32 v49, v82, v83
v_cvt_pk_bf16_f32 v50, v84, v85
v_cvt_pk_bf16_f32 v51, v86, v87
v_exp_f32 v88, v88
v_exp_f32 v89, v89
v_mfma_f32_32x32x16_bf16 v[96:111], v[200:203], v[48:51], v[96:111]
v_exp_f32 v90, v90
v_exp_f32 v91, v91
v_exp_f32 v92, v92
v_exp_f32 v93, v93
v_exp_f32 v94, v94
v_exp_f32 v95, v95
v_cvt_pk_bf16_f32 v52, v88, v89
v_cvt_pk_bf16_f32 v53, v90, v91
v_cvt_pk_bf16_f32 v54, v92, v93
v_cvt_pk_bf16_f32 v55, v94, v95
v_exp_f32 v64, v64
v_exp_f32 v65, v65
v_mfma_f32_32x32x16_bf16 v[96:111], v[204:207], v[52:55], v[96:111]
v_exp_f32 v66, v66
v_exp_f32 v67, v67
v_exp_f32 v68, v68
v_exp_f32_e64 v69, v69
s_waitcnt lgkmcnt(0)
v_mfma_f32_32x32x16_bf16 v[80:95], v[12:15], v[4:7], 0
v_exp_f32 v70, v70
v_exp_f32 v71, v71
v_cvt_pk_bf16_f32 v48, v64, v65
v_cvt_pk_bf16_f32 v49, v66, v67
v_cvt_pk_bf16_f32 v50, v68, v69
v_cvt_pk_bf16_f32 v51, v70, v71
v_exp_f32 v72, v72
v_exp_f32 v73, v73
v_mfma_f32_32x32x16_bf16 v[112:127], v[200:203], v[48:51], v[112:127]
v_exp_f32 v74, v74
v_exp_f32 v75, v75
v_exp_f32 v76, v76
v_exp_f32 v77, v77
v_exp_f32 v78, v78
v_exp_f32 v79, v79
v_cvt_pk_bf16_f32 v52, v72, v73
v_cvt_pk_bf16_f32 v53, v74, v75
v_cvt_pk_bf16_f32 v54, v76, v77
v_cvt_pk_bf16_f32 v55, v78, v79
v_exp_f32 v80, v80
v_exp_f32 v81, v81
v_mfma_f32_32x32x16_bf16 v[112:127], v[204:207], v[52:55], v[112:127]
s_waitcnt vmcnt(0)
s_barrier
ds_read_b128 v[16:19], v216 offset:3072
s_mov_b64 exec, s[72:73]
ds_read_b128 v[200:203], v217 offset:3072
ds_read_b128 v[204:207], v217 offset:3584
s_mov_b64 exec, -1
v_exp_f32 v82, v82
v_exp_f32 v83, v83
v_exp_f32 v84, v84
v_exp_f32 v85, v85
v_mfma_f32_32x32x16_bf16 v[64:79], v[12:15], v[8:11], 0
v_exp_f32 v86, v86
v_exp_f32 v87, v87
v_cvt_pk_bf16_f32 v48, v80, v81
v_cvt_pk_bf16_f32 v49, v82, v83
v_cvt_pk_bf16_f32 v50, v84, v85
v_cvt_pk_bf16_f32 v51, v86, v87
v_exp_f32 v88, v88
v_exp_f32 v89, v89
v_mfma_f32_32x32x16_bf16 v[96:111], v[192:195], v[48:51], v[96:111]
v_exp_f32 v90, v90
v_exp_f32 v91, v91
v_exp_f32 v92, v92
v_exp_f32 v93, v93
v_exp_f32 v94, v94
v_exp_f32 v95, v95
v_cvt_pk_bf16_f32 v52, v88, v89
v_cvt_pk_bf16_f32 v53, v90, v91
v_cvt_pk_bf16_f32 v54, v92, v93
v_cvt_pk_bf16_f32 v55, v94, v95
v_exp_f32 v64, v64
v_exp_f32 v65, v65
v_mfma_f32_32x32x16_bf16 v[96:111], v[196:199], v[52:55], v[96:111]
v_exp_f32 v66, v66
v_exp_f32 v67, v67
v_exp_f32 v68, v68
v_exp_f32_e64 v69, v69
s_waitcnt lgkmcnt(0)
v_mfma_f32_32x32x16_bf16 v[80:95], v[16:19], v[4:7], 0
v_exp_f32 v70, v70
v_exp_f32 v71, v71
v_cvt_pk_bf16_f32 v48, v64, v65
v_cvt_pk_bf16_f32 v49, v66, v67
v_cvt_pk_bf16_f32 v50, v68, v69
v_cvt_pk_bf16_f32 v51, v70, v71
v_exp_f32 v72, v72
v_exp_f32 v73, v73
v_mfma_f32_32x32x16_bf16 v[112:127], v[192:195], v[48:51], v[112:127]
v_exp_f32 v74, v74
v_exp_f32 v75, v75
v_exp_f32 v76, v76
v_exp_f32 v77, v77
v_exp_f32 v78, v78
v_exp_f32 v79, v79
v_cvt_pk_bf16_f32 v52, v72, v73
v_cvt_pk_bf16_f32 v53, v74, v75
v_cvt_pk_bf16_f32 v54, v76, v77
v_cvt_pk_bf16_f32 v55, v78, v79
s_cmp_eq_u32 s5, 1
s_cbranch_scc1 L_exit0_3
v_exp_f32 v80, v80
v_exp_f32 v81, v81
v_mfma_f32_32x32x16_bf16 v[112:127], v[196:199], v[52:55], v[112:127]
ds_read_b128 v[12:15], v216 offset:2048
s_mov_b64 exec, s[72:73]
ds_read_b128 v[192:195], v217 offset:2048
ds_read_b128 v[196:199], v217 offset:2560
s_mov_b64 exec, -1
v_exp_f32 v82, v82
v_exp_f32 v83, v83
v_exp_f32 v84, v84
v_exp_f32 v85, v85
v_mfma_f32_32x32x16_bf16 v[64:79], v[16:19], v[8:11], 0
v_exp_f32 v86, v86
v_exp_f32 v87, v87
v_cvt_pk_bf16_f32 v48, v80, v81
v_cvt_pk_bf16_f32 v49, v82, v83
v_cvt_pk_bf16_f32 v50, v84, v85
v_cvt_pk_bf16_f32 v51, v86, v87
v_exp_f32 v88, v88
v_exp_f32 v89, v89
v_mfma_f32_32x32x16_bf16 v[96:111], v[200:203], v[48:51], v[96:111]
v_exp_f32 v90, v90
v_exp_f32 v91, v91
v_exp_f32 v92, v92
v_exp_f32 v93, v93
v_exp_f32 v94, v94
v_exp_f32 v95, v95
v_cvt_pk_bf16_f32 v52, v88, v89
v_cvt_pk_bf16_f32 v53, v90, v91
v_cvt_pk_bf16_f32 v54, v92, v93
v_cvt_pk_bf16_f32 v55, v94, v95
v_exp_f32 v64, v64
v_exp_f32 v65, v65
v_mfma_f32_32x32x16_bf16 v[96:111], v[204:207], v[52:55], v[96:111]
v_exp_f32 v66, v66
v_exp_f32 v67, v67
v_exp_f32 v68, v68
v_exp_f32_e64 v69, v69
s_waitcnt lgkmcnt(0)
v_mfma_f32_32x32x16_bf16 v[80:95], v[12:15], v[4:7], 0
v_exp_f32 v70, v70
v_exp_f32 v71, v71
v_cvt_pk_bf16_f32 v48, v64, v65
v_cvt_pk_bf16_f32 v49, v66, v67
v_cvt_pk_bf16_f32 v50, v68, v69
v_cvt_pk_bf16_f32 v51, v70, v71
v_exp_f32 v72, v72
v_exp_f32 v73, v73
v_mfma_f32_32x32x16_bf16 v[112:127], v[200:203], v[48:51], v[112:127]
v_exp_f32 v74, v74
v_exp_f32 v75, v75
v_exp_f32 v76, v76
v_exp_f32 v77, v77
v_exp_f32 v78, v78
v_exp_f32 v79, v79
v_cvt_pk_bf16_f32 v52, v72, v73
v_cvt_pk_bf16_f32 v53, v74, v75
v_cvt_pk_bf16_f32 v54, v76, v77
v_cvt_pk_bf16_f32 v55, v78, v79
v_exp_f32 v80, v80
v_exp_f32 v81, v81
v_mfma_f32_32x32x16_bf16 v[112:127], v[204:207], v[52:55], v[112:127]
ds_read_b128 v[16:19], v216 offset:1024
s_mov_b64 exec, s[72:73]
ds_read_b128 v[200:203], v217 offset:1024
ds_read_b128 v[204:207], v217 offset:1536
s_mov_b64 exec, -1
v_exp_f32 v82, v82
v_exp_f32 v83, v83
v_exp_f32 v84, v84
v_exp_f32 v85, v85
v_mfma_f32_32x32x16_bf16 v[64:79], v[12:15], v[8:11], 0
v_exp_f32 v86, v86
v_exp_f32 v87, v87
v_cvt_pk_bf16_f32 v48, v80, v81
v_cvt_pk_bf16_f32 v49, v82, v83
v_cvt_pk_bf16_f32 v50, v84, v85
v_cvt_pk_bf16_f32 v51, v86, v87
v_exp_f32 v88, v88
v_exp_f32 v89, v89
v_mfma_f32_32x32x16_bf16 v[96:111], v[192:195], v[48:51], v[96:111]
v_exp_f32 v90, v90
v_exp_f32 v91, v91
v_exp_f32 v92, v92
v_exp_f32 v93, v93
v_exp_f32 v94, v94
v_exp_f32 v95, v95
v_cvt_pk_bf16_f32 v52, v88, v89
v_cvt_pk_bf16_f32 v53, v90, v91
v_cvt_pk_bf16_f32 v54, v92, v93
v_cvt_pk_bf16_f32 v55, v94, v95
v_exp_f32 v64, v64
v_exp_f32 v65, v65
v_mfma_f32_32x32x16_bf16 v[96:111], v[196:199], v[52:55], v[96:111]
v_exp_f32 v66, v66
v_exp_f32 v67, v67
v_exp_f32 v68, v68
v_exp_f32_e64 v69, v69
s_waitcnt lgkmcnt(0)
v_mfma_f32_32x32x16_bf16 v[80:95], v[16:19], v[4:7], 0
v_exp_f32 v70, v70
v_exp_f32 v71, v71
v_cvt_pk_bf16_f32 v48, v64, v65
v_cvt_pk_bf16_f32 v49, v66, v67
v_cvt_pk_bf16_f32 v50, v68, v69
v_cvt_pk_bf16_f32 v51, v70, v71
v_exp_f32 v72, v72
v_exp_f32 v73, v73
v_mfma_f32_32x32x16_bf16 v[112:127], v[192:195], v[48:51], v[112:127]
v_exp_f32 v74, v74
v_exp_f32 v75, v75
v_exp_f32 v76, v76
v_exp_f32 v77, v77
v_exp_f32 v78, v78
v_exp_f32 v79, v79
v_cvt_pk_bf16_f32 v52, v72, v73
v_cvt_pk_bf16_f32 v53, v74, v75
v_cvt_pk_bf16_f32 v54, v76, v77
v_cvt_pk_bf16_f32 v55, v78, v79
v_exp_f32 v80, v80
v_exp_f32 v81, v81
v_mfma_f32_32x32x16_bf16 v[112:127], v[196:199], v[52:55], v[112:127]
ds_read_b128 v[12:15], v216 offset:0
s_mov_b64 exec, s[72:73]
ds_read_b128 v[192:195], v217 offset:0
ds_read_b128 v[196:199], v217 offset:512
s_mov_b64 exec, -1
v_exp_f32 v82, v82
v_exp_f32 v83, v83
v_exp_f32 v84, v84
v_exp_f32 v85, v85
v_mfma_f32_32x32x16_bf16 v[64:79], v[16:19], v[8:11], v[240:255]
v_exp_f32 v86, v86
v_exp_f32 v87, v87
v_cvt_pk_bf16_f32 v48, v80, v81
v_cvt_pk_bf16_f32 v49, v82, v83
v_cvt_pk_bf16_f32 v50, v84, v85
v_cvt_pk_bf16_f32 v51, v86, v87
v_exp_f32 v88, v88
v_exp_f32 v89, v89
v_mfma_f32_32x32x16_bf16 v[96:111], v[200:203], v[48:51], v[96:111]
v_exp_f32 v90, v90
v_exp_f32 v91, v91
v_exp_f32 v92, v92
v_exp_f32 v93, v93
v_exp_f32 v94, v94
v_exp_f32 v95, v95
v_cvt_pk_bf16_f32 v52, v88, v89
v_cvt_pk_bf16_f32 v53, v90, v91
v_cvt_pk_bf16_f32 v54, v92, v93
v_cvt_pk_bf16_f32 v55, v94, v95
v_exp_f32 v64, v64
v_exp_f32 v65, v65
v_mfma_f32_32x32x16_bf16 v[96:111], v[204:207], v[52:55], v[96:111]
v_exp_f32 v66, v66
v_exp_f32 v67, v67
v_exp_f32 v68, v68
v_exp_f32_e64 v69, v69
s_waitcnt lgkmcnt(0)
v_mfma_f32_32x32x16_bf16 v[80:95], v[12:15], v[4:7], v[240:255]
v_exp_f32 v70, v70
v_exp_f32 v71, v71
v_cvt_pk_bf16_f32 v48, v64, v65
v_cvt_pk_bf16_f32 v49, v66, v67
v_cvt_pk_bf16_f32 v50, v68, v69
v_cvt_pk_bf16_f32 v51, v70, v71
v_exp_f32 v72, v72
v_exp_f32 v73, v73
v_mfma_f32_32x32x16_bf16 v[112:127], v[200:203], v[48:51], v[112:127]
v_exp_f32 v74, v74
v_exp_f32 v75, v75
v_exp_f32 v76, v76
v_exp_f32 v77, v77
v_exp_f32 v78, v78
v_exp_f32 v79, v79
v_cvt_pk_bf16_f32 v52, v72, v73
v_cvt_pk_bf16_f32 v53, v74, v75
v_cvt_pk_bf16_f32 v54, v76, v77
v_cvt_pk_bf16_f32 v55, v78, v79
v_exp_f32 v80, v80
v_exp_f32 v81, v81
v_mfma_f32_32x32x16_bf16 v[112:127], v[204:207], v[52:55], v[112:127]
v_exp_f32 v82, v82
v_exp_f32 v83, v83
v_exp_f32 v84, v84
v_exp_f32 v85, v85
v_exp_f32 v86, v86
v_exp_f32 v87, v87
v_cvt_pk_bf16_f32 v48, v80, v81
v_cvt_pk_bf16_f32 v49, v82, v83
v_cvt_pk_bf16_f32 v50, v84, v85
v_cvt_pk_bf16_f32 v51, v86, v87
v_exp_f32 v88, v88
v_exp_f32 v89, v89
v_mfma_f32_32x32x16_bf16 v[96:111], v[192:195], v[48:51], v[96:111]
v_exp_f32 v90, v90
v_exp_f32 v91, v91
v_exp_f32 v92, v92
v_exp_f32 v93, v93
v_exp_f32 v94, v94
v_exp_f32 v95, v95
v_cvt_pk_bf16_f32 v52, v88, v89
v_cvt_pk_bf16_f32 v53, v90, v91
v_cvt_pk_bf16_f32 v54, v92, v93
v_cvt_pk_bf16_f32 v55, v94, v95
s_nop 1
v_mfma_f32_32x32x16_bf16 v[96:111], v[196:199], v[52:55], v[96:111]
L_finB:
v_rcp_f32 v137, v120
s_mov_b32 s56, 0x2b800000
s_mov_b32 s57, 0x28000000
v_pk_mul_f32 v[112:113], v[112:113], v[136:137] op_sel:[0,1]
v_pk_mul_f32 v[114:115], v[114:115], v[136:137] op_sel:[0,1]
v_pk_mul_f32 v[116:117], v[116:117], v[136:137] op_sel:[0,1]
v_pk_mul_f32 v[118:119], v[118:119], v[136:137] op_sel:[0,1]
v_cvt_pk_bf16_f32 v48, v112, v113
v_cvt_pk_bf16_f32 v49, v114, v115
v_cvt_pk_bf16_f32 v50, v116, v117
v_cvt_pk_bf16_f32 v51, v118, v119
buffer_store_dwordx4 v[48:51], v208, s[40:43], s71 offen sc1
v_subrev_u32 v138, s56, v120
v_rcp_f32 v137, v104
v_subrev_u32_e64 v136, s56, v104
v_pk_mul_f32 v[96:97], v[96:97], v[136:137] op_sel:[0,1]
v_pk_mul_f32 v[98:99], v[98:99], v[136:137] op_sel:[0,1]
v_pk_mul_f32 v[100:101], v[100:101], v[136:137] op_sel:[0,1]
v_pk_mul_f32 v[102:103], v[102:103], v[136:137] op_sel:[0,1]
v_cvt_pk_bf16_f32 v52, v96, v97
v_cvt_pk_bf16_f32 v53, v98, v99
v_cvt_pk_bf16_f32 v54, v100, v101
v_cvt_pk_bf16_f32 v55, v102, v103
buffer_store_dwordx4 v[52:55], v208, s[40:43], s70 offen sc1
v_max_u32 v136, v136, v138
v_cmp_lt_u32 vcc, s57, v136
s_nop 1
s_cmp_lg_u64 vcc, 0
s_cbranch_scc1 L_exact
L_attdone:
s_cmp_lt_u32 s3, 4
s_cbranch_scc1 L_tail0
v_mov_b32 v2, s10
v_mov_b32 v3, s11
s_lshl_b32 s56, s14, 3
s_lshl_b64 exec, 0xff, s56
s_waitcnt vmcnt(0)
s_barrier
buffer_store_dwordx2 v[2:3], v214, s[40:43], s68 offen sc1
s_mov_b64 exec, -1
s_branch L_fin
L_exit2_7:
s_nop 0
v_mfma_f32_32x32x16_bf16 v[112:127], v[196:199], v[52:55], v[112:127]
s_waitcnt lgkmcnt(0)
s_nop 7
s_nop 1
s_branch L_finB
L_exit2_3:
s_nop 0
v_mfma_f32_32x32x16_bf16 v[112:127], v[196:199], v[52:55], v[112:127]
s_waitcnt lgkmcnt(0)
s_nop 7
s_nop 1
s_branch L_finB
L_exit0_7:
s_nop 0
v_mfma_f32_32x32x16_bf16 v[112:127], v[196:199], v[52:55], v[112:127]
s_waitcnt lgkmcnt(0)
s_nop 7
s_nop 1
s_branch L_finB
L_exit0_3:
s_nop 0
v_mfma_f32_32x32x16_bf16 v[112:127], v[196:199], v[52:55], v[112:127]
s_waitcnt lgkmcnt(0)
s_nop 7
s_nop 1
s_branch L_finB
L_retire:
v_lshlrev_b32_e64 v4, 9, v1
v_add_u32 v4, 8192, v4
s_mov_b32 s74, 4194304
s_mov_b64 exec, -1
L_pr0:
buffer_load_dwordx2 v[2:3], v4, s[40:43], 0 offen sc1
L_pr0_w:
s_waitcnt vmcnt(0)
v_cmp_ne_u64 vcc, s[10:11], v[2:3]
s_sub_u32 s74, s74, 1
s_cbranch_scc1 L_pr0_done
s_nop 1
s_cmp_eq_u64 vcc, 0
s_cbranch_scc1 L_pr0_done
s_branch L_pr0
L_pr0_done:
s_mov_b64 exec, -1
v_add_u32 v4, 0x8000, v4
s_mov_b32 s74, 4194304
s_mov_b64 exec, -1
L_pr1:
buffer_load_dwordx2 v[2:3], v4, s[40:43], 0 offen sc1
L_pr1_w:
s_waitcnt vmcnt(0)
v_cmp_ne_u64 vcc, s[10:11], v[2:3]
s_sub_u32 s74, s74, 1
s_cbranch_scc1 L_pr1_done
s_nop 1
s_cmp_eq_u64 vcc, 0
s_cbranch_scc1 L_pr1_done
s_branch L_pr1
L_pr1_done:
s_mov_b64 exec, -1
v_lshlrev_b32_e64 v4, 3, v1
v_add_u32 v4, 1024, v4
s_mov_b32 s74, 4194304
s_mov_b64 exec, -1
L_pr2:
buffer_load_dwordx2 v[2:3], v4, s[40:43], 0 offen sc1
L_pr2_w:
s_waitcnt vmcnt(0)
v_cmp_ne_u64 vcc, s[10:11], v[2:3]
s_sub_u32 s74, s74, 1
s_cbranch_scc1 L_pr2_done
s_nop 1
s_cmp_eq_u64 vcc, 0
s_cbranch_scc1 L_pr2_done
s_branch L_pr2
L_pr2_done:
s_mov_b64 exec, -1
v_add_u32 v4, 512, v4
s_mov_b32 s74, 4194304
s_mov_b64 exec, -1
L_pr3:
buffer_load_dwordx2 v[2:3], v4, s[40:43], 0 offen sc1
L_pr3_w:
s_waitcnt vmcnt(0)
v_cmp_ne_u64 vcc, s[10:11], v[2:3]
s_sub_u32 s74, s74, 1
s_cbranch_scc1 L_pr3_done
s_nop 1
s_cmp_eq_u64 vcc, 0
s_cbranch_scc1 L_pr3_done
s_branch L_pr3
L_pr3_done:
s_mov_b64 exec, -1
s_mov_b32 s57, 0
v_mov_b32 v2, s10
v_mov_b32 v3, s11
s_mov_b64 exec, 1
buffer_store_dwordx2 v[2:3], off, s[40:43], s57 sc1
s_mov_b64 exec, -1
s_branch L_tail2
.p2align 12
L_tail0:
L_tail:
s_setprio 0
s_lshl_b32 s59, s13, 1
s_and_b32 s57, s14, 1
s_add_u32 s59, s59, s57
s_lshl_b32 s59, s59, 15
s_lshr_b32 s57, s14, 1
s_lshl_b32 s57, s57, 14
s_add_u32 s59, s59, s57
s_add_u32 s59, s59, 8388608
s_mov_b32 s60, 0
s_lshl_b32 s69, s60, 13
s_add_u32 s59, s59, s69
s_lshr_b32 s56, s14, 1
s_lshl_b32 s57, s56, 15
s_add_u32 s57, s57, 98304
s_lshl_b32 s58, s60, 14
s_add_u32 s57, s57, s58
v_add_u32 v216, s57, v211
v_xor_b32_e64 v217, 64, v216
ds_read_b64_tr_b16 v[64:65], v216 offset:0
ds_read_b64_tr_b16 v[66:67], v216 offset:1024
ds_read_b64_tr_b16 v[68:69], v217 offset:0
ds_read_b64_tr_b16 v[70:71], v217 offset:1024
ds_read_b64_tr_b16 v[72:73], v216 offset:2048
ds_read_b64_tr_b16 v[74:75], v216 offset:3072
ds_read_b64_tr_b16 v[76:77], v217 offset:2048
ds_read_b64_tr_b16 v[78:79], v217 offset:3072
ds_read_b64_tr_b16 v[80:81], v216 offset:4096
ds_read_b64_tr_b16 v[82:83], v216 offset:5120
ds_read_b64_tr_b16 v[84:85], v217 offset:4096
ds_read_b64_tr_b16 v[86:87], v217 offset:5120
ds_read_b64_tr_b16 v[88:89], v216 offset:6144
ds_read_b64_tr_b16 v[90:91], v216 offset:7168
ds_read_b64_tr_b16 v[92:93], v217 offset:6144
ds_read_b64_tr_b16 v[94:95], v217 offset:7168
ds_read_b64_tr_b16 v[96:97], v216 offset:8192
ds_read_b64_tr_b16 v[98:99], v216 offset:9216
ds_read_b64_tr_b16 v[100:101], v217 offset:8192
ds_read_b64_tr_b16 v[102:103], v217 offset:9216
ds_read_b64_tr_b16 v[104:105], v216 offset:10240
ds_read_b64_tr_b16 v[106:107], v216 offset:11264
ds_read_b64_tr_b16 v[108:109], v217 offset:10240
ds_read_b64_tr_b16 v[110:111], v217 offset:11264
ds_read_b64_tr_b16 v[112:113], v216 offset:12288
ds_read_b64_tr_b16 v[114:115], v216 offset:13312
ds_read_b64_tr_b16 v[116:117], v217 offset:12288
ds_read_b64_tr_b16 v[118:119], v217 offset:13312
ds_read_b64_tr_b16 v[120:121], v216 offset:14336
ds_read_b64_tr_b16 v[122:123], v216 offset:15360
ds_read_b64_tr_b16 v[124:125], v217 offset:14336
ds_read_b64_tr_b16 v[126:127], v217 offset:15360
v_xor_b32 v216, 0x4000, v216
v_xor_b32 v217, 0x4000, v217
ds_read_b64_tr_b16 v[128:129], v216 offset:0
ds_read_b64_tr_b16 v[130:131], v216 offset:1024
ds_read_b64_tr_b16 v[132:133], v217 offset:0
ds_read_b64_tr_b16 v[134:135], v217 offset:1024
ds_read_b64_tr_b16 v[136:137], v216 offset:2048
ds_read_b64_tr_b16 v[138:139], v216 offset:3072
ds_read_b64_tr_b16 v[140:141], v217 offset:2048
ds_read_b64_tr_b16 v[142:143], v217 offset:3072
ds_read_b64_tr_b16 v[144:145], v216 offset:4096
ds_read_b64_tr_b16 v[146:147], v216 offset:5120
ds_read_b64_tr_b16 v[148:149], v217 offset:4096
ds_read_b64_tr_b16 v[150:151], v217 offset:5120
ds_read_b64_tr_b16 v[152:153], v216 offset:6144
ds_read_b64_tr_b16 v[154:155], v216 offset:7168
ds_read_b64_tr_b16 v[156:157], v217 offset:6144
ds_read_b64_tr_b16 v[158:159], v217 offset:7168
s_cmp_lg_u32 s4, 0
s_cbranch_scc1 L_nfj
s_waitcnt vmcnt(0)
s_barrier
L_nfj:
ds_read_b64_tr_b16 v[160:161], v216 offset:8192
ds_read_b64_tr_b16 v[162:163], v216 offset:9216
ds_read_b64_tr_b16 v[164:165], v217 offset:8192
ds_read_b64_tr_b16 v[166:167], v217 offset:9216
ds_read_b64_tr_b16 v[168:169], v216 offset:10240
ds_read_b64_tr_b16 v[170:171], v216 offset:11264
ds_read_b64_tr_b16 v[172:173], v217 offset:10240
ds_read_b64_tr_b16 v[174:175], v217 offset:11264
ds_read_b64_tr_b16 v[176:177], v216 offset:12288
ds_read_b64_tr_b16 v[178:179], v216 offset:13312
ds_read_b64_tr_b16 v[180:181], v217 offset:12288
ds_read_b64_tr_b16 v[182:183], v217 offset:13312
ds_read_b64_tr_b16 v[184:185], v216 offset:14336
ds_read_b64_tr_b16 v[186:187], v216 offset:15360
ds_read_b64_tr_b16 v[188:189], v217 offset:14336
ds_read_b64_tr_b16 v[190:191], v217 offset:15360
s_lshl_b32 s64, s13, 1
s_and_b32 s57, s14, 1
s_add_u32 s64, s64, s57
s_lshl_b32 s64, s64, 16
s_lshr_b32 s57, s9, 2
s_lshl_b32 s57, s57, 7
s_add_u32 s64, s64, s57
s_lshl_b32 s57, s56, 15
s_add_u32 s64, s64, s57
s_add_u32 s64, s64, 1024
s_lshl_b32 s57, s14, 12
s_add_u32 s57, s57, 81920
v_add_u32_e64 v196, s57, v208
s_xor_b32 s57, s57, 8192
s_waitcnt lgkmcnt(0)
v_add_u32 v218, s57, v208
v_and_b32 v2, 31, v1
v_lshrrev_b32 v3, 5, v1
v_bfe_u32 v216, v1, 1, 2
v_xor_b32 v3, v3, v216
v_lshlrev_b32 v3, 4, v3
v_lshl_add_u32 v2, v2, 6, v3
v_add_u32 v216, s57, v2
v_xor_b32 v217, 32, v216
s_add_u32 s65, s64, 16384
s_and_b32 s57, s14, 1
s_lshl_b32 s57, s57, 12
s_lshl_b32 s56, s56, 10
s_add_u32 s57, s57, s56
s_add_u32 s57, s57, 90112
v_lshrrev_b32_e64 v2, 3, v1
v_bfe_u32 v3, v1, 2, 1
v_and_b32 v197, 3, v1
v_lshrrev_b32 v212, 4, v1
v_xor_b32 v212, v212, v197
v_lshlrev_b32 v212, 4, v212
v_lshl_add_u32 v212, v3, 6, v212
v_lshl_add_u32 v212, v2, 11, v212
v_lshl_add_u32 v197, v197, 4, s57
v_lshl_add_u32 v197, v2, 6, v197
v_lshlrev_b32 v3, 13, v3
v_sub_u32 v197, v197, v3
s_waitcnt vmcnt(0)
s_barrier
s_cmp_eq_u32 s4, 0
s_cbranch_scc1 L_compA2
s_lshl_b32 s56, s2, 3
s_add_u32 s56, s56, s3
s_cmp_lg_u32 s56, 8
s_cbranch_scc0 L_retire
L_noret:
L_tail2:
s_mov_b32 s74, 4194304
L_pob:
L_pob_f:
s_load_dwordx8 s[24:31], s[40:41], s7 offset:0 glc
L_pob_w:
s_sub_u32 s74, s74, 1
s_waitcnt lgkmcnt(0)
s_cbranch_scc1 L_pob_d
L_pob_c:
s_cmp_eq_u64 s[24:25], s[10:11]
s_cbranch_scc0 L_pob
s_cmp_eq_u64 s[26:27], s[10:11]
s_cbranch_scc0 L_pob
s_cmp_eq_u64 s[28:29], s[10:11]
s_cbranch_scc0 L_pob
s_cmp_eq_u64 s[30:31], s[10:11]
s_cbranch_scc0 L_pob
L_pob_d:
buffer_load_dwordx4 v[4:7], v208, s[40:43], s59 offen offset:0 sc1
buffer_load_dwordx4 v[8:11], v208, s[40:43], s59 offen offset:1024 sc1
buffer_load_dwordx4 v[12:15], v208, s[40:43], s59 offen offset:2048 sc1
buffer_load_dwordx4 v[16:19], v208, s[40:43], s59 offen offset:3072 sc1
s_xor_b32 s59, s59, 4096
buffer_load_dwordx4 v[20:23], v208, s[40:43], s59 offen offset:0 sc1
buffer_load_dwordx4 v[24:27], v208, s[40:43], s59 offen offset:1024 sc1
buffer_load_dwordx4 v[28:31], v208, s[40:43], s59 offen offset:2048 sc1
buffer_load_dwordx4 v[32:35], v208, s[40:43], s59 offen offset:3072 sc1
s_xor_b32 s59, s59, 12288
buffer_load_dwordx4 v[36:39], v208, s[40:43], s59 offen offset:0 sc1
buffer_load_dwordx4 v[40:43], v208, s[40:43], s59 offen offset:1024 sc1
buffer_load_dwordx4 v[44:47], v208, s[40:43], s59 offen offset:2048 sc1
buffer_load_dwordx4 v[48:51], v208, s[40:43], s59 offen offset:3072 sc1
s_xor_b32 s59, s59, 4096
buffer_load_dwordx4 v[52:55], v208, s[40:43], s59 offen offset:0 sc1
buffer_load_dwordx4 v[56:59], v208, s[40:43], s59 offen offset:1024 sc1
buffer_load_dwordx4 v[60:63], v208, s[40:43], s59 offen offset:2048 sc1
buffer_load_dwordx4 v[192:195], v208, s[40:43], s59 offen offset:3072 sc1
v_mov_b32 v2, 98304
v_mov_b32_e64 v3, 16
s_mov_b64 exec, 1
ds_add_u32 v2, v3
s_mov_b64 exec, -1
s_waitcnt vmcnt(15)
v_mfma_f32_32x32x16_bf16 v[240:255], v[68:71], v[4:7], 0
v_mfma_f32_32x32x16_bf16 v[224:239], v[64:67], v[4:7], 0
s_waitcnt vmcnt(14)
v_mfma_f32_32x32x16_bf16 v[240:255], v[76:79], v[8:11], v[240:255]
v_mfma_f32_32x32x16_bf16 v[224:239], v[72:75], v[8:11], v[224:239]
s_waitcnt vmcnt(13)
v_mfma_f32_32x32x16_bf16 v[240:255], v[84:87], v[12:15], v[240:255]
v_mfma_f32_32x32x16_bf16 v[224:239], v[80:83], v[12:15], v[224:239]
s_waitcnt vmcnt(12)
v_mfma_f32_32x32x16_bf16 v[240:255], v[92:95], v[16:19], v[240:255]
v_mfma_f32_32x32x16_bf16 v[224:239], v[88:91], v[16:19], v[224:239]
s_waitcnt vmcnt(11)
v_mfma_f32_32x32x16_bf16 v[240:255], v[100:103], v[20:23], v[240:255]
v_mfma_f32_32x32x16_bf16 v[224:239], v[96:99], v[20:23], v[224:239]
s_waitcnt vmcnt(10)
v_mfma_f32_32x32x16_bf16 v[240:255], v[108:111], v[24:27], v[240:255]
v_mfma_f32_32x32x16_bf16 v[224:239], v[104:107], v[24:27], v[224:239]
s_waitcnt vmcnt(9)
v_mfma_f32_32x32x16_bf16 v[240:255], v[116:119], v[28:31], v[240:255]
s_waitcnt vmcnt(8)
v_mfma_f32_32x32x16_bf16 v[240:255], v[124:127], v[32:35], v[240:255]
s_waitcnt vmcnt(7)
v_mfma_f32_32x32x16_bf16 v[240:255], v[132:135], v[36:39], v[240:255]
s_waitcnt vmcnt(6)
v_mfma_f32_32x32x16_bf16 v[240:255], v[140:143], v[40:43], v[240:255]
s_waitcnt vmcnt(5)
v_mfma_f32_32x32x16_bf16 v[240:255], v[148:151], v[44:47], v[240:255]
s_waitcnt vmcnt(4)
v_mfma_f32_32x32x16_bf16 v[240:255], v[156:159], v[48:51], v[240:255]
s_waitcnt vmcnt(3)
v_mfma_f32_32x32x16_bf16 v[240:255], v[164:167], v[52:55], v[240:255]
s_waitcnt vmcnt(2)
v_mfma_f32_32x32x16_bf16 v[240:255], v[172:175], v[56:59], v[240:255]
s_waitcnt vmcnt(1)
v_mfma_f32_32x32x16_bf16 v[240:255], v[180:183], v[60:63], v[240:255]
s_waitcnt vmcnt(0)
v_mfma_f32_32x32x16_bf16 v[240:255], v[188:191], v[192:195], v[240:255]
v_mfma_f32_32x32x16_bf16 v[224:239], v[112:115], v[28:31], v[224:239]
v_mfma_f32_32x32x16_bf16 v[224:239], v[120:123], v[32:35], v[224:239]
v_mfma_f32_32x32x16_bf16 v[224:239], v[128:131], v[36:39], v[224:239]
s_nop 8
ds_write_b128 v196, v[240:243] offset:0
v_mfma_f32_32x32x16_bf16 v[224:239], v[136:139], v[40:43], v[224:239]
ds_write_b128 v196, v[244:247] offset:1024
v_mfma_f32_32x32x16_bf16 v[224:239], v[144:147], v[44:47], v[224:239]
ds_write_b128 v196, v[248:251] offset:2048
v_mfma_f32_32x32x16_bf16 v[224:239], v[152:155], v[48:51], v[224:239]
ds_write_b128 v196, v[252:255] offset:3072
v_mfma_f32_32x32x16_bf16 v[224:239], v[160:163], v[52:55], v[224:239]
s_waitcnt lgkmcnt(0)
s_barrier
ds_read_b128 v[68:71], v218 offset:0
ds_read_b128 v[76:79], v218 offset:1024
ds_read_b128 v[84:87], v218 offset:2048
ds_read_b128 v[92:95], v218 offset:3072
v_mfma_f32_32x32x16_bf16 v[224:239], v[168:171], v[56:59], v[224:239]
v_mfma_f32_32x32x16_bf16 v[224:239], v[176:179], v[60:63], v[224:239]
v_mfma_f32_32x32x16_bf16 v[224:239], v[184:187], v[192:195], v[224:239]
s_waitcnt lgkmcnt(0)
s_nop 7
s_nop 2
s_nop 0
v_pk_add_f32 v[224:225], v[224:225], v[68:69]
v_pk_add_f32 v[226:227], v[226:227], v[70:71]
v_pk_add_f32 v[228:229], v[228:229], v[76:77]
v_pk_add_f32 v[230:231], v[230:231], v[78:79]
v_pk_add_f32 v[232:233], v[232:233], v[84:85]
v_pk_add_f32 v[234:235], v[234:235], v[86:87]
v_pk_add_f32 v[236:237], v[236:237], v[92:93]
v_pk_add_f32 v[238:239], v[238:239], v[94:95]
v_cvt_pk_bf16_f32 v4, v224, v225
v_cvt_pk_bf16_f32 v5, v226, v227
v_cvt_pk_bf16_f32 v6, v228, v229
v_cvt_pk_bf16_f32 v7, v230, v231
v_cvt_pk_bf16_f32 v8, v232, v233
v_cvt_pk_bf16_f32 v9, v234, v235
v_cvt_pk_bf16_f32 v10, v236, v237
v_cvt_pk_bf16_f32 v11, v238, v239
s_nop 1
v_permlane32_swap_b32 v4, v6
v_permlane32_swap_b32 v5, v7
v_permlane32_swap_b32 v8, v10
v_permlane32_swap_b32_e64 v9, v11
ds_write_b128 v216, v[4:7]
ds_write_b128 v217, v[8:11]
s_waitcnt lgkmcnt(0)
s_barrier
ds_read_b128 v[20:23], v197
ds_read_b128 v[24:27], v197 offset:512
s_waitcnt lgkmcnt(1)
buffer_store_dwordx4 v[20:23], v212, s[44:47], s64 offen sc1
s_waitcnt lgkmcnt(0)
buffer_store_dwordx4 v[24:27], v212, s[44:47], s65 offen sc1
L_fin:
L_end:
s_endpgm
L_exact:
s_waitcnt vmcnt(0)
s_mov_b32 s66, 0
s_lshl_b32 s56, s55, 10
v_add_u32 v216, s56, v216
v_add_u32 v217, s56, v217
v_mov_b32 v40, v4
v_mov_b32 v41, v5
v_mov_b32 v42, v6
v_mov_b32_e64 v43, v7
L_unitX:
s_lshl_b32 s56, s5, 2
s_add_u32 s56, s56, s55
s_add_u32 s56, s56, s66
s_sub_u32 s67, 8, s56
s_cselect_b32 s67, 0, s67
ds_read_b128 v[176:179], v216 offset:8192
ds_read_b128 v[172:175], v216 offset:7168
ds_read_b128 v[168:171], v216 offset:6144
ds_read_b128 v[164:167], v216 offset:5120
ds_read_b128 v[160:163], v216 offset:4096
ds_read_b128 v[156:159], v216 offset:3072
ds_read_b128 v[152:155], v216 offset:2048
ds_read_b128 v[148:151], v216 offset:1024
ds_read_b128 v[144:147], v216 offset:0
s_mov_b64 exec, s[72:73]
ds_read_b128 v[192:195], v217 offset:8192
ds_read_b128 v[196:199], v217 offset:8704
s_mov_b64 exec, -1
s_waitcnt lgkmcnt(2)
v_mfma_f32_32x32x16_bf16 v[64:79], v[176:179], v[40:43], v[224:239]
v_mfma_f32_32x32x16_bf16 v[80:95], v[172:175], v[40:43], 0
s_nop 7
s_nop 2
v_max_f32 v137, v64, v65
v_max_f32_e64 v138, v66, v67
v_max3_f32 v137, v68, v69, v137
v_max3_f32 v138, v70, v71, v138
v_max3_f32 v137, v72, v73, v137
v_max3_f32 v138, v74, v75, v138
v_max3_f32 v137, v76, v77, v137
v_max3_f32 v138, v78, v79, v138
s_cmp_eq_u32 s67, 8
s_cbranch_scc1 L_p1done
s_nop 0
v_mfma_f32_32x32x16_bf16 v[64:79], v[168:171], v[40:43], 0
v_max3_f32 v137, v80, v81, v137
v_max3_f32 v138, v82, v83, v138
v_max3_f32 v137, v84, v85, v137
v_max3_f32 v138, v86, v87, v138
v_max3_f32 v137, v88, v89, v137
v_max3_f32 v138, v90, v91, v138
v_max3_f32 v137, v92, v93, v137
v_max3_f32 v138, v94, v95, v138
s_cmp_eq_u32 s67, 7
s_cbranch_scc1 L_p1done
s_nop 0
v_mfma_f32_32x32x16_bf16 v[80:95], v[164:167], v[40:43], 0
v_max3_f32 v137, v64, v65, v137
v_max3_f32 v138, v66, v67, v138
v_max3_f32 v137, v68, v69, v137
v_max3_f32 v138, v70, v71, v138
v_max3_f32 v137, v72, v73, v137
v_max3_f32 v138, v74, v75, v138
v_max3_f32 v137, v76, v77, v137
v_max3_f32 v138, v78, v79, v138
s_cmp_eq_u32 s67, 6
s_cbranch_scc1 L_p1done
s_nop 0
v_mfma_f32_32x32x16_bf16 v[64:79], v[160:163], v[40:43], 0
v_max3_f32 v137, v80, v81, v137
v_max3_f32 v138, v82, v83, v138
v_max3_f32 v137, v84, v85, v137
v_max3_f32 v138, v86, v87, v138
v_max3_f32 v137, v88, v89, v137
v_max3_f32 v138, v90, v91, v138
v_max3_f32 v137, v92, v93, v137
v_max3_f32 v138, v94, v95, v138
s_cmp_eq_u32 s67, 5
s_cbranch_scc1 L_p1done
s_nop 0
v_mfma_f32_32x32x16_bf16 v[80:95], v[156:159], v[40:43], 0
v_max3_f32 v137, v64, v65, v137
v_max3_f32 v138, v66, v67, v138
v_max3_f32 v137, v68, v69, v137
v_max3_f32 v138, v70, v71, v138
v_max3_f32 v137, v72, v73, v137
v_max3_f32 v138, v74, v75, v138
v_max3_f32 v137, v76, v77, v137
v_max3_f32 v138, v78, v79, v138
s_cmp_eq_u32 s67, 4
s_cbranch_scc1 L_p1done
s_nop 0
v_mfma_f32_32x32x16_bf16 v[64:79], v[152:155], v[40:43], 0
v_max3_f32 v137, v80, v81, v137
v_max3_f32 v138, v82, v83, v138
v_max3_f32 v137, v84, v85, v137
v_max3_f32 v138, v86, v87, v138
v_max3_f32 v137, v88, v89, v137
v_max3_f32 v138, v90, v91, v138
v_max3_f32 v137, v92, v93, v137
v_max3_f32 v138, v94, v95, v138
s_cmp_eq_u32 s67, 3
s_cbranch_scc1 L_p1done
s_nop 0
v_mfma_f32_32x32x16_bf16 v[80:95], v[148:151], v[40:43], 0
v_max3_f32 v137, v64, v65, v137
v_max3_f32 v138, v66, v67, v138
v_max3_f32 v137, v68, v69, v137
v_max3_f32 v138, v70, v71, v138
v_max3_f32 v137, v72, v73, v137
v_max3_f32 v138, v74, v75, v138
v_max3_f32 v137, v76, v77, v137
v_max3_f32 v138, v78, v79, v138
s_cmp_eq_u32 s67, 2
s_cbranch_scc1 L_p1done
s_nop 0
v_mfma_f32_32x32x16_bf16 v[64:79], v[144:147], v[40:43], v[240:255]
v_max3_f32 v137, v80, v81, v137
v_max3_f32 v138, v82, v83, v138
v_max3_f32 v137, v84, v85, v137
v_max3_f32 v138, v86, v87, v138
v_max3_f32 v137, v88, v89, v137
v_max3_f32 v138, v90, v91, v138
v_max3_f32 v137, v92, v93, v137
v_max3_f32 v138, v94, v95, v138
s_cmp_eq_u32 s67, 1
s_cbranch_scc1 L_p1done
s_nop 0
s_nop 1
s_nop 0
v_max3_f32 v137, v64, v65, v137
v_max3_f32 v138, v66, v67, v138
v_max3_f32 v137, v68, v69, v137
v_max3_f32 v138, v70, v71, v138
v_max3_f32 v137, v72, v73, v137
v_max3_f32 v138, v74, v75, v138
v_max3_f32 v137, v76, v77, v137
v_max3_f32 v138, v78, v79, v138
L_p1done:
v_max_f32 v137, v137, v138
v_mov_b32 v138, v137
s_nop 1
v_permlane32_swap_b32 v137, v138
s_nop 1
v_max_f32 v137, v137, v138
v_sub_f32 v64, v224, v137
v_sub_f32 v65, v225, v137
v_sub_f32 v66, v226, v137
v_sub_f32 v67, v227, v137
v_sub_f32 v68, v228, v137
v_sub_f32 v69, v229, v137
v_sub_f32 v70, v230, v137
v_sub_f32 v71, v231, v137
v_sub_f32 v72, v232, v137
v_sub_f32 v73, v233, v137
v_sub_f32 v74, v234, v137
v_sub_f32 v75, v235, v137
v_sub_f32 v76, v236, v137
v_sub_f32 v77, v237, v137
v_sub_f32 v78, v238, v137
v_sub_f32 v79, v239, v137
v_sub_f32 v112, 0, v137
v_sub_f32 v113, 0, v137
v_mfma_f32_32x32x16_bf16 v[64:79], v[176:179], v[40:43], v[64:79]
v_sub_f32 v114, 0, v137
v_sub_f32 v115, 0, v137
v_sub_f32 v116, 0, v137
v_sub_f32 v117, 0, v137
v_sub_f32 v118, 0, v137
v_sub_f32 v119, 0, v137
v_sub_f32 v120, 0, v137
v_sub_f32 v121, 0, v137
v_sub_f32 v122, 0, v137
v_sub_f32 v123, 0, v137
v_sub_f32 v124, 0, v137
v_sub_f32 v125, 0, v137
v_sub_f32 v126, 0, v137
v_sub_f32_e64 v127, 0, v137
s_nop 1
v_mfma_f32_32x32x16_bf16 v[80:95], v[172:175], v[40:43], v[112:127]
s_mov_b64 exec, s[72:73]
ds_read_b128 v[200:203], v217 offset:7168
ds_read_b128 v[204:207], v217 offset:7680
s_mov_b64 exec, -1
v_exp_f32 v64, v64
v_exp_f32 v65, v65
v_exp_f32 v66, v66
v_exp_f32 v67, v67
v_exp_f32 v68, v68
v_exp_f32 v69, v69
v_exp_f32 v70, v70
v_exp_f32 v71, v71
v_cvt_pk_bf16_f32 v48, v64, v65
v_cvt_pk_bf16_f32 v49, v66, v67
v_cvt_pk_bf16_f32 v50, v68, v69
v_cvt_pk_bf16_f32 v51, v70, v71
s_waitcnt lgkmcnt(2)
s_nop 0
v_mfma_f32_32x32x16_bf16 v[96:111], v[192:195], v[48:51], 0
v_exp_f32 v72, v72
v_exp_f32 v73, v73
v_exp_f32 v74, v74
v_exp_f32 v75, v75
v_exp_f32 v76, v76
v_exp_f32 v77, v77
v_exp_f32 v78, v78
v_exp_f32 v79, v79
v_cvt_pk_bf16_f32 v52, v72, v73
v_cvt_pk_bf16_f32 v53, v74, v75
v_cvt_pk_bf16_f32 v54, v76, v77
v_cvt_pk_bf16_f32 v55, v78, v79
s_nop 1
v_mfma_f32_32x32x16_bf16 v[96:111], v[196:199], v[52:55], v[96:111]
s_cmp_eq_u32 s67, 8
s_cbranch_scc1 L_p2done
v_mfma_f32_32x32x16_bf16 v[64:79], v[168:171], v[40:43], v[112:127]
s_mov_b64 exec, s[72:73]
ds_read_b128 v[192:195], v217 offset:6144
ds_read_b128 v[196:199], v217 offset:6656
s_mov_b64 exec, -1
v_exp_f32 v80, v80
v_exp_f32 v81, v81
v_exp_f32 v82, v82
v_exp_f32 v83, v83
v_exp_f32 v84, v84
v_exp_f32 v85, v85
v_exp_f32 v86, v86
v_exp_f32_e64 v87, v87
v_cvt_pk_bf16_f32 v48, v80, v81
v_cvt_pk_bf16_f32 v49, v82, v83
v_cvt_pk_bf16_f32 v50, v84, v85
v_cvt_pk_bf16_f32 v51, v86, v87
s_waitcnt lgkmcnt(2)
s_nop 0
v_mfma_f32_32x32x16_bf16 v[96:111], v[200:203], v[48:51], v[96:111]
v_exp_f32 v88, v88
v_exp_f32 v89, v89
v_exp_f32 v90, v90
v_exp_f32 v91, v91
v_exp_f32 v92, v92
v_exp_f32 v93, v93
v_exp_f32 v94, v94
v_exp_f32 v95, v95
v_cvt_pk_bf16_f32 v52, v88, v89
v_cvt_pk_bf16_f32 v53, v90, v91
v_cvt_pk_bf16_f32 v54, v92, v93
v_cvt_pk_bf16_f32 v55, v94, v95
s_nop 1
v_mfma_f32_32x32x16_bf16 v[96:111], v[204:207], v[52:55], v[96:111]
s_cmp_eq_u32 s67, 7
s_cbranch_scc1 L_p2done
v_mfma_f32_32x32x16_bf16 v[80:95], v[164:167], v[40:43], v[112:127]
s_mov_b64 exec, s[72:73]
ds_read_b128 v[200:203], v217 offset:5120
ds_read_b128 v[204:207], v217 offset:5632
s_mov_b64 exec, -1
v_exp_f32 v64, v64
v_exp_f32 v65, v65
v_exp_f32 v66, v66
v_exp_f32 v67, v67
v_exp_f32 v68, v68
v_exp_f32 v69, v69
v_exp_f32 v70, v70
v_exp_f32_e64 v71, v71
v_cvt_pk_bf16_f32 v48, v64, v65
v_cvt_pk_bf16_f32 v49, v66, v67
v_cvt_pk_bf16_f32 v50, v68, v69
v_cvt_pk_bf16_f32 v51, v70, v71
s_waitcnt lgkmcnt(2)
s_nop 0
v_mfma_f32_32x32x16_bf16 v[96:111], v[192:195], v[48:51], v[96:111]
v_exp_f32 v72, v72
v_exp_f32 v73, v73
v_exp_f32 v74, v74
v_exp_f32 v75, v75
v_exp_f32 v76, v76
v_exp_f32 v77, v77
v_exp_f32 v78, v78
v_exp_f32 v79, v79
v_cvt_pk_bf16_f32 v52, v72, v73
v_cvt_pk_bf16_f32 v53, v74, v75
v_cvt_pk_bf16_f32 v54, v76, v77
v_cvt_pk_bf16_f32 v55, v78, v79
s_nop 1
v_mfma_f32_32x32x16_bf16 v[96:111], v[196:199], v[52:55], v[96:111]
s_cmp_eq_u32 s67, 6
s_cbranch_scc1 L_p2done
v_mfma_f32_32x32x16_bf16 v[64:79], v[160:163], v[40:43], v[112:127]
s_mov_b64 exec, s[72:73]
ds_read_b128 v[192:195], v217 offset:4096
ds_read_b128 v[196:199], v217 offset:4608
s_mov_b64 exec, -1
v_exp_f32 v80, v80
v_exp_f32 v81, v81
v_exp_f32 v82, v82
v_exp_f32 v83, v83
v_exp_f32 v84, v84
v_exp_f32 v85, v85
v_exp_f32 v86, v86
v_exp_f32_e64 v87, v87
v_cvt_pk_bf16_f32 v48, v80, v81
v_cvt_pk_bf16_f32 v49, v82, v83
v_cvt_pk_bf16_f32 v50, v84, v85
v_cvt_pk_bf16_f32 v51, v86, v87
s_waitcnt lgkmcnt(2)
s_nop 0
v_mfma_f32_32x32x16_bf16 v[96:111], v[200:203], v[48:51], v[96:111]
v_exp_f32 v88, v88
v_exp_f32 v89, v89
v_exp_f32 v90, v90
v_exp_f32 v91, v91
v_exp_f32 v92, v92
v_exp_f32 v93, v93
v_exp_f32 v94, v94
v_exp_f32 v95, v95
v_cvt_pk_bf16_f32 v52, v88, v89
v_cvt_pk_bf16_f32 v53, v90, v91
v_cvt_pk_bf16_f32 v54, v92, v93
v_cvt_pk_bf16_f32 v55, v94, v95
s_nop 1
v_mfma_f32_32x32x16_bf16 v[96:111], v[204:207], v[52:55], v[96:111]
s_cmp_eq_u32 s67, 5
s_cbranch_scc1 L_p2done
v_mfma_f32_32x32x16_bf16 v[80:95], v[156:159], v[40:43], v[112:127]
s_mov_b64 exec, s[72:73]
ds_read_b128 v[200:203], v217 offset:3072
ds_read_b128 v[204:207], v217 offset:3584
s_mov_b64 exec, -1
v_exp_f32 v64, v64
v_exp_f32 v65, v65
v_exp_f32 v66, v66
v_exp_f32 v67, v67
v_exp_f32 v68, v68
v_exp_f32 v69, v69
v_exp_f32 v70, v70
v_exp_f32_e64 v71, v71
v_cvt_pk_bf16_f32 v48, v64, v65
v_cvt_pk_bf16_f32 v49, v66, v67
v_cvt_pk_bf16_f32 v50, v68, v69
v_cvt_pk_bf16_f32 v51, v70, v71
s_waitcnt lgkmcnt(2)
s_nop 0
v_mfma_f32_32x32x16_bf16 v[96:111], v[192:195], v[48:51], v[96:111]
v_exp_f32 v72, v72
v_exp_f32 v73, v73
v_exp_f32 v74, v74
v_exp_f32 v75, v75
v_exp_f32 v76, v76
v_exp_f32 v77, v77
v_exp_f32 v78, v78
v_exp_f32 v79, v79
v_cvt_pk_bf16_f32 v52, v72, v73
v_cvt_pk_bf16_f32 v53, v74, v75
v_cvt_pk_bf16_f32 v54, v76, v77
v_cvt_pk_bf16_f32 v55, v78, v79
s_nop 1
v_mfma_f32_32x32x16_bf16 v[96:111], v[196:199], v[52:55], v[96:111]
s_cmp_eq_u32 s67, 4
s_cbranch_scc1 L_p2done
v_mfma_f32_32x32x16_bf16 v[64:79], v[152:155], v[40:43], v[112:127]
s_mov_b64 exec, s[72:73]
ds_read_b128 v[192:195], v217 offset:2048
ds_read_b128 v[196:199], v217 offset:2560
s_mov_b64 exec, -1
v_exp_f32 v80, v80
v_exp_f32 v81, v81
v_exp_f32 v82, v82
v_exp_f32 v83, v83
v_exp_f32 v84, v84
v_exp_f32 v85, v85
v_exp_f32 v86, v86
v_exp_f32_e64 v87, v87
v_cvt_pk_bf16_f32 v48, v80, v81
v_cvt_pk_bf16_f32 v49, v82, v83
v_cvt_pk_bf16_f32 v50, v84, v85
v_cvt_pk_bf16_f32 v51, v86, v87
s_waitcnt lgkmcnt(2)
s_nop 0
v_mfma_f32_32x32x16_bf16 v[96:111], v[200:203], v[48:51], v[96:111]
v_exp_f32 v88, v88
v_exp_f32 v89, v89
v_exp_f32 v90, v90
v_exp_f32 v91, v91
v_exp_f32 v92, v92
v_exp_f32 v93, v93
v_exp_f32 v94, v94
v_exp_f32 v95, v95
v_cvt_pk_bf16_f32 v52, v88, v89
v_cvt_pk_bf16_f32 v53, v90, v91
v_cvt_pk_bf16_f32 v54, v92, v93
v_cvt_pk_bf16_f32 v55, v94, v95
s_nop 1
v_mfma_f32_32x32x16_bf16 v[96:111], v[204:207], v[52:55], v[96:111]
s_cmp_eq_u32 s67, 3
s_cbranch_scc1 L_p2done
v_mfma_f32_32x32x16_bf16 v[80:95], v[148:151], v[40:43], v[112:127]
s_mov_b64 exec, s[72:73]
ds_read_b128 v[200:203], v217 offset:1024
ds_read_b128 v[204:207], v217 offset:1536
s_mov_b64 exec, -1
v_exp_f32 v64, v64
v_exp_f32 v65, v65
v_exp_f32 v66, v66
v_exp_f32 v67, v67
v_exp_f32 v68, v68
v_exp_f32 v69, v69
v_exp_f32 v70, v70
v_exp_f32_e64 v71, v71
v_cvt_pk_bf16_f32 v48, v64, v65
v_cvt_pk_bf16_f32 v49, v66, v67
v_cvt_pk_bf16_f32 v50, v68, v69
v_cvt_pk_bf16_f32 v51, v70, v71
s_waitcnt lgkmcnt(2)
s_nop 0
v_mfma_f32_32x32x16_bf16 v[96:111], v[192:195], v[48:51], v[96:111]
v_exp_f32 v72, v72
v_exp_f32 v73, v73
v_exp_f32 v74, v74
v_exp_f32 v75, v75
v_exp_f32 v76, v76
v_exp_f32 v77, v77
v_exp_f32 v78, v78
v_exp_f32 v79, v79
v_cvt_pk_bf16_f32 v52, v72, v73
v_cvt_pk_bf16_f32 v53, v74, v75
v_cvt_pk_bf16_f32 v54, v76, v77
v_cvt_pk_bf16_f32 v55, v78, v79
s_nop 1
v_mfma_f32_32x32x16_bf16 v[96:111], v[196:199], v[52:55], v[96:111]
s_cmp_eq_u32 s67, 2
s_cbranch_scc1 L_p2done
v_sub_f32 v64, v240, v137
v_sub_f32 v65, v241, v137
v_sub_f32 v66, v242, v137
v_sub_f32 v67, v243, v137
v_sub_f32 v68, v244, v137
v_sub_f32 v69, v245, v137
v_sub_f32 v70, v246, v137
v_sub_f32 v71, v247, v137
v_sub_f32 v72, v248, v137
v_sub_f32 v73, v249, v137
v_sub_f32 v74, v250, v137
v_sub_f32 v75, v251, v137
v_sub_f32 v76, v252, v137
v_sub_f32 v77, v253, v137
v_sub_f32 v78, v254, v137
v_sub_f32 v79, v255, v137
s_nop 1
v_mfma_f32_32x32x16_bf16 v[64:79], v[144:147], v[40:43], v[64:79]
s_mov_b64 exec, s[72:73]
ds_read_b128 v[192:195], v217 offset:0
ds_read_b128 v[196:199], v217 offset:512
s_mov_b64 exec, -1
v_exp_f32 v80, v80
v_exp_f32 v81, v81
v_exp_f32 v82, v82
v_exp_f32 v83, v83
v_exp_f32 v84, v84
v_exp_f32 v85, v85
v_exp_f32 v86, v86
v_exp_f32 v87, v87
v_cvt_pk_bf16_f32 v48, v80, v81
v_cvt_pk_bf16_f32 v49, v82, v83
v_cvt_pk_bf16_f32 v50, v84, v85
v_cvt_pk_bf16_f32 v51, v86, v87
s_waitcnt lgkmcnt(2)
s_nop 0
v_mfma_f32_32x32x16_bf16 v[96:111], v[200:203], v[48:51], v[96:111]
v_exp_f32 v88, v88
v_exp_f32 v89, v89
v_exp_f32 v90, v90
v_exp_f32 v91, v91
v_exp_f32 v92, v92
v_exp_f32 v93, v93
v_exp_f32 v94, v94
v_exp_f32 v95, v95
v_cvt_pk_bf16_f32 v52, v88, v89
v_cvt_pk_bf16_f32 v53, v90, v91
v_cvt_pk_bf16_f32 v54, v92, v93
v_cvt_pk_bf16_f32 v55, v94, v95
s_nop 1
v_mfma_f32_32x32x16_bf16 v[96:111], v[204:207], v[52:55], v[96:111]
s_cmp_eq_u32 s67, 1
s_cbranch_scc1 L_p2done
v_exp_f32 v64, v64
v_exp_f32 v65, v65
v_exp_f32 v66, v66
v_exp_f32 v67, v67
v_exp_f32 v68, v68
v_exp_f32 v69, v69
v_exp_f32 v70, v70
v_exp_f32_e64 v71, v71
v_cvt_pk_bf16_f32 v48, v64, v65
v_cvt_pk_bf16_f32 v49, v66, v67
v_cvt_pk_bf16_f32 v50, v68, v69
v_cvt_pk_bf16_f32 v51, v70, v71
s_waitcnt lgkmcnt(0)
s_nop 0
v_mfma_f32_32x32x16_bf16 v[96:111], v[192:195], v[48:51], v[96:111]
v_exp_f32 v72, v72
v_exp_f32 v73, v73
v_exp_f32 v74, v74
v_exp_f32 v75, v75
v_exp_f32 v76, v76
v_exp_f32 v77, v77
v_exp_f32 v78, v78
v_exp_f32 v79, v79
v_cvt_pk_bf16_f32 v52, v72, v73
v_cvt_pk_bf16_f32 v53, v74, v75
v_cvt_pk_bf16_f32 v54, v76, v77
v_cvt_pk_bf16_f32 v55, v78, v79
s_nop 1
v_mfma_f32_32x32x16_bf16 v[96:111], v[196:199], v[52:55], v[96:111]
L_p2done:
s_waitcnt lgkmcnt(0)
s_nop 7
s_nop 2
v_rcp_f32 v136, v104
s_nop 0
v_mul_f32 v96, v136, v96
v_mul_f32 v97, v136, v97
v_mul_f32 v98, v136, v98
v_mul_f32 v99, v136, v99
v_mul_f32 v100, v136, v100
v_mul_f32 v101, v136, v101
v_mul_f32 v102, v136, v102
v_mul_f32 v103, v136, v103
v_cvt_pk_bf16_f32 v48, v96, v97
v_cvt_pk_bf16_f32 v49, v98, v99
v_cvt_pk_bf16_f32 v50, v100, v101
v_cvt_pk_bf16_f32 v51, v102, v103
buffer_store_dwordx4 v[48:51], v208, s[40:43], s70 offen sc1
v_mov_b32 v40, v8
v_mov_b32 v41, v9
v_mov_b32 v42, v10
v_mov_b32 v43, v11
v_add_u32 v216, 1024, v216
v_add_u32 v217, 1024, v217
s_mov_b32 s70, s71
s_add_u32 s66, s66, 1
s_cmp_lt_u32 s66, 2
s_cbranch_scc1 L_unitX
s_branch L_attdone
.section .rodata,"a"
.p2align 6
.amdhsa_kernel concat_heads__sliding_local_dilated__sliding_block__prompt_kernel
  .amdhsa_next_free_vgpr 256
  .amdhsa_next_free_sgpr 102
  .amdhsa_accum_offset 256
  .amdhsa_group_segment_fixed_size 0
  .amdhsa_kernarg_size 72
  .amdhsa_user_sgpr_count 2
  .amdhsa_user_sgpr_kernarg_segment_ptr 1
  .amdhsa_system_sgpr_workgroup_id_x 1
.end_amdhsa_kernel
```
